```python
import torch

def _softmax(x, axis=-1):
    return torch.softmax(x, dim=axis)
def _gelu(x):
    return torch.nn.functional.gelu(x, approximate="tanh")
def _silu(x):
    return torch.nn.functional.silu(x)
def _sigmoid(x):
    return torch.sigmoid(x)
def _layernorm(x, axis=-1, eps=1e-5):
    m = x.mean(dim=axis, keepdim=True)
    v = x.var(dim=axis, keepdim=True, unbiased=False)
    return (x - m) / torch.sqrt(v + eps)
def _scatter_add(tgt, idx, src, axis=0):
    return tgt.clone().index_add_(axis, idx, src)
def _segment_sum(src, seg, n):
    out = torch.zeros((n,) + src.shape[1:], dtype=src.dtype)
    return out.index_add_(0, seg, src)
def _pad(x, pw):
    flat = tuple(v for pair in reversed(pw) for v in pair)
    return torch.nn.functional.pad(x, flat)

kernel_name = 'standalone__gqa_softmax__near_ridge'

def setup_inputs():

    _w = (lambda a: (lambda t: t.to(torch.bfloat16) if t.is_floating_point() else t)(torch.as_tensor(a)))
    B, Hq, Hkv, Sq, Sk, D = 64, 32, 8, 256, 256, 128
    return {
        "q": _w((lambda *s: torch.randn(*s, dtype=torch.bfloat16) * 0.8)(B, Hq, Sq, D)),
        "k": _w((lambda *s: torch.randn(*s, dtype=torch.bfloat16) * 0.8)(B, Hkv, Sk, D)),
        "v": _w((lambda *s: torch.randn(*s, dtype=torch.bfloat16) * 0.05)(B, Hkv, Sk, D)),
    }

def reference(q, k, v):
    B, Hq, Sq, D = q.shape
    Hkv = k.shape[1]
    rep = Hq // Hkv
    k = (lambda x, n, axis: torch.repeat_interleave(x, n, dim=axis))(k, rep, axis=1)
    v = (lambda x, n, axis: torch.repeat_interleave(x, n, dim=axis))(v, rep, axis=1)
    scale = D ** -0.5
    scores = torch.einsum("bhqd,bhkd->bhqk", q, k) * scale
    p = _softmax(scores, axis=-1)
    return torch.einsum("bhqk,bhkd->bhqd", p, v)
```

```asm
; @launch grid=(256,1,1) block=(512,1,1) lds=163840
.amdgcn_target "amdgcn-amd-amdhsa--gfx950"
.text
.globl standalone__gqa_softmax__near_ridge_kernel
.p2align 8
.type standalone__gqa_softmax__near_ridge_kernel,@function
standalone__gqa_softmax__near_ridge_kernel:
    s_cmp_ge_u32 s2, 256
    s_cbranch_scc1 L_end
    s_load_dwordx8 s[4:11], s[0:1], 0
    v_lshrrev_b32 v15, 6, v0
    v_and_b32 v0, 63, v0
    s_nop 0
    v_readfirstlane_b32 s28, v15
    s_mov_b32 s32, 0x3e0293ee
    s_waitcnt lgkmcnt(0)
    s_mov_b32 s12, s4
    s_mov_b32 s13, s5
    s_mov_b32 s14, 0x8000000
    s_mov_b32 s15, 0x00020000
    s_mov_b32 s16, s6
    s_mov_b32 s17, s7
    s_mov_b32 s18, 0x2000000
    s_mov_b32 s19, 0x00020000
    s_mov_b32 s20, s8
    s_mov_b32 s21, s9
    s_mov_b32 s22, 0x2000000
    s_mov_b32 s23, 0x00020000
    s_mov_b32 s24, s10
    s_mov_b32 s25, s11
    s_mov_b32 s26, 0x8000000
    s_mov_b32 s27, 0x00020000
    v_and_b32 v116, 15, v0
    v_lshrrev_b32 v117, 4, v0
    s_and_b32 s33, s28, 3
    s_lshl_b32 s33, s33, 2
    v_add_u32 v112, s33, v117
    v_xor_b32 v112, v112, v116
    v_lshlrev_b32 v112, 4, v112
    v_lshl_add_u32 v245, v117, 8, v112
    v_lshlrev_b32 v113, 2, v117
    v_xor_b32 v113, v113, v116
    v_lshlrev_b32 v113, 4, v113
    v_lshl_add_u32 v246, v117, 8, v113
    s_lshl_b32 s35, s2, 16
    s_lshl_b32 s40, s28, 10
    s_add_u32 s35, s35, s40
    s_lshl_b32 s30, s2, 18
    s_lshl_b32 s33, s28, 15
    s_add_u32 s30, s30, s33
    v_and_b32 v118, 31, v0
    v_lshrrev_b32 v119, 5, v0
    v_lshlrev_b32 v112, 4, v119
    v_lshl_add_u32 v1, v118, 8, v112
    s_add_u32 m0, s40, 0
    s_add_u32 s33, s35, 0
    buffer_load_dwordx4 v245, s[16:19], s33 offen lds
    s_add_u32 m0, s40, 8192
    s_add_u32 s33, s35, 8192
    buffer_load_dwordx4 v245, s[16:19], s33 offen lds
    s_add_u32 m0, s40, 16384
    s_add_u32 s33, s35, 16384
    buffer_load_dwordx4 v245, s[16:19], s33 offen lds
    s_add_u32 m0, s40, 24576
    s_add_u32 s33, s35, 24576
    buffer_load_dwordx4 v245, s[16:19], s33 offen lds
    s_add_u32 m0, s40, 32768
    s_add_u32 s33, s35, 32768
    buffer_load_dwordx4 v245, s[16:19], s33 offen lds
    s_add_u32 m0, s40, 40960
    s_add_u32 s33, s35, 40960
    buffer_load_dwordx4 v245, s[16:19], s33 offen lds
    s_add_u32 m0, s40, 49152
    s_add_u32 s33, s35, 49152
    buffer_load_dwordx4 v245, s[16:19], s33 offen lds
    s_add_u32 m0, s40, 57344
    s_add_u32 s33, s35, 57344
    buffer_load_dwordx4 v245, s[16:19], s33 offen lds
    buffer_load_dwordx4 v[16:19], v1, s[12:15], s30 offen offset:0
    buffer_load_dwordx4 v[20:23], v1, s[12:15], s30 offen offset:32
    buffer_load_dwordx4 v[24:27], v1, s[12:15], s30 offen offset:64
    buffer_load_dwordx4 v[28:31], v1, s[12:15], s30 offen offset:96
    buffer_load_dwordx4 v[32:35], v1, s[12:15], s30 offen offset:128
    buffer_load_dwordx4 v[36:39], v1, s[12:15], s30 offen offset:160
    buffer_load_dwordx4 v[40:43], v1, s[12:15], s30 offen offset:192
    buffer_load_dwordx4 v[44:47], v1, s[12:15], s30 offen offset:224
    s_add_u32 m0, s40, 65536
    s_add_u32 s33, s35, 0
    buffer_load_dwordx4 v246, s[20:23], s33 offen lds
    s_add_u32 m0, s40, 73728
    s_add_u32 s33, s35, 8192
    buffer_load_dwordx4 v246, s[20:23], s33 offen lds
    s_add_u32 m0, s40, 81920
    s_add_u32 s33, s35, 16384
    buffer_load_dwordx4 v246, s[20:23], s33 offen lds
    s_add_u32 m0, s40, 90112
    s_add_u32 s33, s35, 24576
    buffer_load_dwordx4 v246, s[20:23], s33 offen lds
    s_add_u32 m0, s40, 98304
    s_add_u32 s33, s35, 32768
    buffer_load_dwordx4 v246, s[20:23], s33 offen lds
    s_add_u32 m0, s40, 106496
    s_add_u32 s33, s35, 40960
    buffer_load_dwordx4 v246, s[20:23], s33 offen lds
    s_add_u32 m0, s40, 114688
    s_add_u32 s33, s35, 49152
    buffer_load_dwordx4 v246, s[20:23], s33 offen lds
    s_add_u32 m0, s40, 122880
    s_add_u32 s33, s35, 57344
    buffer_load_dwordx4 v246, s[20:23], s33 offen lds
    s_add_u32 s34, s30, 8192
    buffer_load_dwordx4 v[48:51], v1, s[12:15], s34 offen offset:0
    buffer_load_dwordx4 v[52:55], v1, s[12:15], s34 offen offset:32
    buffer_load_dwordx4 v[56:59], v1, s[12:15], s34 offen offset:64
    buffer_load_dwordx4 v[60:63], v1, s[12:15], s34 offen offset:96
    buffer_load_dwordx4 v[64:67], v1, s[12:15], s34 offen offset:128
    buffer_load_dwordx4 v[68:71], v1, s[12:15], s34 offen offset:160
    buffer_load_dwordx4 v[72:75], v1, s[12:15], s34 offen offset:192
    buffer_load_dwordx4 v[76:79], v1, s[12:15], s34 offen offset:224
    v_and_b32 v113, 15, v118
    v_add_u32 v112, 0, v119
    v_xor_b32 v112, v112, v113
    v_lshlrev_b32 v112, 4, v112
    v_lshl_add_u32 v3, v118, 8, v112
    v_add_u32 v112, 2, v119
    v_xor_b32 v112, v112, v113
    v_lshlrev_b32 v112, 4, v112
    v_lshl_add_u32 v4, v118, 8, v112
    v_add_u32 v112, 4, v119
    v_xor_b32 v112, v112, v113
    v_lshlrev_b32 v112, 4, v112
    v_lshl_add_u32 v5, v118, 8, v112
    v_add_u32 v112, 6, v119
    v_xor_b32 v112, v112, v113
    v_lshlrev_b32 v112, 4, v112
    v_lshl_add_u32 v6, v118, 8, v112
    v_add_u32 v112, 8, v119
    v_xor_b32 v112, v112, v113
    v_lshlrev_b32 v112, 4, v112
    v_lshl_add_u32 v7, v118, 8, v112
    v_add_u32 v112, 10, v119
    v_xor_b32 v112, v112, v113
    v_lshlrev_b32 v112, 4, v112
    v_lshl_add_u32 v8, v118, 8, v112
    v_add_u32 v112, 12, v119
    v_xor_b32 v112, v112, v113
    v_lshlrev_b32 v112, 4, v112
    v_lshl_add_u32 v9, v118, 8, v112
    v_add_u32 v112, 14, v119
    v_xor_b32 v112, v112, v113
    v_lshlrev_b32 v112, 4, v112
    v_lshl_add_u32 v10, v118, 8, v112
    v_lshrrev_b32 v120, 2, v116
    v_and_b32 v121, 3, v116
    v_and_b32 v122, 1, v117
    v_and_b32 v112, 1, v121
    v_lshl_add_u32 v112, v112, 1, v122
    v_add_u32 v112, 0, v112
    v_lshlrev_b32 v113, 2, v120
    v_xor_b32 v112, v112, v113
    v_lshlrev_b32 v112, 4, v112
    v_lshrrev_b32 v113, 1, v121
    v_lshl_add_u32 v112, v113, 3, v112
    v_lshl_add_u32 v113, v119, 2, v120
    v_lshl_add_u32 v112, v113, 8, v112
    v_add_u32 v11, 0x10000, v112
    v_and_b32 v112, 1, v121
    v_lshl_add_u32 v112, v112, 1, v122
    v_add_u32 v112, 4, v112
    v_lshlrev_b32 v113, 2, v120
    v_xor_b32 v112, v112, v113
    v_lshlrev_b32 v112, 4, v112
    v_lshrrev_b32 v113, 1, v121
    v_lshl_add_u32 v112, v113, 3, v112
    v_lshl_add_u32 v113, v119, 2, v120
    v_lshl_add_u32 v112, v113, 8, v112
    v_add_u32 v12, 0x10000, v112
    v_and_b32 v112, 1, v121
    v_lshl_add_u32 v112, v112, 1, v122
    v_add_u32 v112, 8, v112
    v_lshlrev_b32 v113, 2, v120
    v_xor_b32 v112, v112, v113
    v_lshlrev_b32 v112, 4, v112
    v_lshrrev_b32 v113, 1, v121
    v_lshl_add_u32 v112, v113, 3, v112
    v_lshl_add_u32 v113, v119, 2, v120
    v_lshl_add_u32 v112, v113, 8, v112
    v_add_u32 v13, 0x10000, v112
    v_and_b32 v112, 1, v121
    v_lshl_add_u32 v112, v112, 1, v122
    v_add_u32 v112, 12, v112
    v_lshlrev_b32 v113, 2, v120
    v_xor_b32 v112, v112, v113
    v_lshlrev_b32 v112, 4, v112
    v_lshrrev_b32 v113, 1, v121
    v_lshl_add_u32 v112, v113, 3, v112
    v_lshl_add_u32 v113, v119, 2, v120
    v_lshl_add_u32 v112, v113, 8, v112
    v_add_u32 v14, 0x10000, v112
    s_lshl_b32 s33, s28, 12
    s_add_u32 s33, s33, 0x20000
    v_and_b32 v112, 7, v118
    v_lshlrev_b32 v113, 1, v119
    v_xor_b32 v112, v112, v113
    v_lshlrev_b32 v112, 4, v112
    v_lshl_add_u32 v112, v118, 7, v112
    v_add_u32 v240, s33, v112
    v_xor_b32 v241, 16, v240
    v_xor_b32 v242, 64, v240
    v_xor_b32 v243, 80, v240
    v_lshrrev_b32 v112, 3, v0
    v_and_b32 v113, 7, v0
    v_lshlrev_b32 v244, 4, v113
    v_lshl_add_u32 v244, v112, 8, v244
    v_xor_b32 v113, v113, v112
    v_lshlrev_b32 v113, 4, v113
    v_lshl_add_u32 v113, v112, 7, v113
    v_add_u32 v2, s33, v113
    s_mov_b32 s29, 0
L_group:
    s_waitcnt vmcnt(16)
    s_waitcnt vmcnt(24)
    s_barrier
    ds_read_b128 v[80:83], v3 offset:0
    ds_read_b128 v[84:87], v4 offset:0
    ds_read_b128 v[88:91], v5 offset:0
    ds_read_b128 v[92:95], v6 offset:0
    ds_read_b128 v[96:99], v7 offset:0
    s_waitcnt lgkmcnt(4)
    v_mfma_f32_32x32x16_bf16 v[112:127], v[80:83], v[16:19], 0
    ds_read_b128 v[100:103], v8 offset:0
    s_waitcnt lgkmcnt(4)
    v_mfma_f32_32x32x16_bf16 v[112:127], v[84:87], v[20:23], v[112:127]
    ds_read_b128 v[80:83], v9 offset:0
    s_waitcnt lgkmcnt(4)
    v_mfma_f32_32x32x16_bf16 v[112:127], v[88:91], v[24:27], v[112:127]
    ds_read_b128 v[84:87], v10 offset:0
    s_waitcnt lgkmcnt(4)
    v_mfma_f32_32x32x16_bf16 v[112:127], v[92:95], v[28:31], v[112:127]
    ds_read_b128 v[88:91], v3 offset:8192
    s_waitcnt lgkmcnt(4)
    v_mfma_f32_32x32x16_bf16 v[112:127], v[96:99], v[32:35], v[112:127]
    ds_read_b128 v[92:95], v4 offset:8192
    s_waitcnt lgkmcnt(4)
    v_mfma_f32_32x32x16_bf16 v[112:127], v[100:103], v[36:39], v[112:127]
    ds_read_b128 v[96:99], v5 offset:8192
    s_waitcnt lgkmcnt(4)
    v_mfma_f32_32x32x16_bf16 v[112:127], v[80:83], v[40:43], v[112:127]
    ds_read_b128 v[100:103], v6 offset:8192
    s_waitcnt lgkmcnt(4)
    v_mfma_f32_32x32x16_bf16 v[112:127], v[84:87], v[44:47], v[112:127]
    ds_read_b128 v[80:83], v7 offset:8192
    s_waitcnt lgkmcnt(4)
    v_mfma_f32_32x32x16_bf16 v[128:143], v[88:91], v[16:19], 0
    ds_read_b128 v[84:87], v8 offset:8192
    s_waitcnt lgkmcnt(4)
    v_mfma_f32_32x32x16_bf16 v[128:143], v[92:95], v[20:23], v[128:143]
    ds_read_b128 v[88:91], v9 offset:8192
    s_waitcnt lgkmcnt(4)
    v_mfma_f32_32x32x16_bf16 v[128:143], v[96:99], v[24:27], v[128:143]
    ds_read_b128 v[92:95], v10 offset:8192
    s_waitcnt lgkmcnt(4)
    v_mfma_f32_32x32x16_bf16 v[128:143], v[100:103], v[28:31], v[128:143]
    ds_read_b128 v[96:99], v3 offset:16384
    s_waitcnt lgkmcnt(4)
    v_mfma_f32_32x32x16_bf16 v[128:143], v[80:83], v[32:35], v[128:143]
    ds_read_b128 v[100:103], v4 offset:16384
    s_waitcnt lgkmcnt(4)
    v_mfma_f32_32x32x16_bf16 v[128:143], v[84:87], v[36:39], v[128:143]
    ds_read_b128 v[80:83], v5 offset:16384
    s_waitcnt lgkmcnt(4)
    v_mfma_f32_32x32x16_bf16 v[128:143], v[88:91], v[40:43], v[128:143]
    ds_read_b128 v[84:87], v6 offset:16384
    s_waitcnt lgkmcnt(4)
    v_mfma_f32_32x32x16_bf16 v[128:143], v[92:95], v[44:47], v[128:143]
    ds_read_b128 v[88:91], v7 offset:16384
    s_waitcnt lgkmcnt(4)
    v_mfma_f32_32x32x16_bf16 v[144:159], v[96:99], v[16:19], 0
    ds_read_b128 v[92:95], v8 offset:16384
    s_waitcnt lgkmcnt(4)
    v_mfma_f32_32x32x16_bf16 v[144:159], v[100:103], v[20:23], v[144:159]
    ds_read_b128 v[96:99], v9 offset:16384
    s_waitcnt lgkmcnt(4)
    v_mfma_f32_32x32x16_bf16 v[144:159], v[80:83], v[24:27], v[144:159]
    ds_read_b128 v[100:103], v10 offset:16384
    s_waitcnt lgkmcnt(4)
    v_mfma_f32_32x32x16_bf16 v[144:159], v[84:87], v[28:31], v[144:159]
    ds_read_b128 v[80:83], v3 offset:24576
    s_waitcnt lgkmcnt(4)
    v_mfma_f32_32x32x16_bf16 v[144:159], v[88:91], v[32:35], v[144:159]
    ds_read_b128 v[84:87], v4 offset:24576
    s_waitcnt lgkmcnt(4)
    v_mfma_f32_32x32x16_bf16 v[144:159], v[92:95], v[36:39], v[144:159]
    ds_read_b128 v[88:91], v5 offset:24576
    s_waitcnt lgkmcnt(4)
    v_mfma_f32_32x32x16_bf16 v[144:159], v[96:99], v[40:43], v[144:159]
    ds_read_b128 v[92:95], v6 offset:24576
    s_waitcnt lgkmcnt(4)
    v_mfma_f32_32x32x16_bf16 v[144:159], v[100:103], v[44:47], v[144:159]
    ds_read_b128 v[96:99], v7 offset:24576
    s_waitcnt lgkmcnt(4)
    v_mfma_f32_32x32x16_bf16 v[160:175], v[80:83], v[16:19], 0
    ds_read_b128 v[100:103], v8 offset:24576
    s_waitcnt lgkmcnt(4)
    v_mfma_f32_32x32x16_bf16 v[160:175], v[84:87], v[20:23], v[160:175]
    ds_read_b128 v[80:83], v9 offset:24576
    s_waitcnt lgkmcnt(4)
    v_mfma_f32_32x32x16_bf16 v[160:175], v[88:91], v[24:27], v[160:175]
    ds_read_b128 v[84:87], v10 offset:24576
    s_waitcnt lgkmcnt(4)
    v_mfma_f32_32x32x16_bf16 v[160:175], v[92:95], v[28:31], v[160:175]
    ds_read_b128 v[88:91], v3 offset:32768
    s_waitcnt lgkmcnt(4)
    v_mfma_f32_32x32x16_bf16 v[160:175], v[96:99], v[32:35], v[160:175]
    ds_read_b128 v[92:95], v4 offset:32768
    s_waitcnt lgkmcnt(4)
    v_mfma_f32_32x32x16_bf16 v[160:175], v[100:103], v[36:39], v[160:175]
    ds_read_b128 v[96:99], v5 offset:32768
    s_waitcnt lgkmcnt(4)
    v_mfma_f32_32x32x16_bf16 v[160:175], v[80:83], v[40:43], v[160:175]
    ds_read_b128 v[100:103], v6 offset:32768
    s_waitcnt lgkmcnt(4)
    v_mfma_f32_32x32x16_bf16 v[160:175], v[84:87], v[44:47], v[160:175]
    ds_read_b128 v[80:83], v7 offset:32768
    s_waitcnt lgkmcnt(4)
    v_mfma_f32_32x32x16_bf16 v[176:191], v[88:91], v[16:19], 0
    ds_read_b128 v[84:87], v8 offset:32768
    s_waitcnt lgkmcnt(4)
    v_mfma_f32_32x32x16_bf16 v[176:191], v[92:95], v[20:23], v[176:191]
    ds_read_b128 v[88:91], v9 offset:32768
    s_waitcnt lgkmcnt(4)
    v_mfma_f32_32x32x16_bf16 v[176:191], v[96:99], v[24:27], v[176:191]
    ds_read_b128 v[92:95], v10 offset:32768
    s_waitcnt lgkmcnt(4)
    v_mfma_f32_32x32x16_bf16 v[176:191], v[100:103], v[28:31], v[176:191]
    ds_read_b128 v[96:99], v3 offset:40960
    s_waitcnt lgkmcnt(4)
    v_mfma_f32_32x32x16_bf16 v[176:191], v[80:83], v[32:35], v[176:191]
    ds_read_b128 v[100:103], v4 offset:40960
    s_waitcnt lgkmcnt(4)
    v_mfma_f32_32x32x16_bf16 v[176:191], v[84:87], v[36:39], v[176:191]
    ds_read_b128 v[80:83], v5 offset:40960
    s_waitcnt lgkmcnt(4)
    v_mfma_f32_32x32x16_bf16 v[176:191], v[88:91], v[40:43], v[176:191]
    ds_read_b128 v[84:87], v6 offset:40960
    s_waitcnt lgkmcnt(4)
    v_mfma_f32_32x32x16_bf16 v[176:191], v[92:95], v[44:47], v[176:191]
    ds_read_b128 v[88:91], v7 offset:40960
    s_waitcnt lgkmcnt(4)
    v_mfma_f32_32x32x16_bf16 v[192:207], v[96:99], v[16:19], 0
    ds_read_b128 v[92:95], v8 offset:40960
    s_waitcnt lgkmcnt(4)
    v_mfma_f32_32x32x16_bf16 v[192:207], v[100:103], v[20:23], v[192:207]
    ds_read_b128 v[96:99], v9 offset:40960
    s_waitcnt lgkmcnt(4)
    v_mfma_f32_32x32x16_bf16 v[192:207], v[80:83], v[24:27], v[192:207]
    ds_read_b128 v[100:103], v10 offset:40960
    s_waitcnt lgkmcnt(4)
    v_mfma_f32_32x32x16_bf16 v[192:207], v[84:87], v[28:31], v[192:207]
    ds_read_b128 v[80:83], v3 offset:49152
    s_waitcnt lgkmcnt(4)
    v_mfma_f32_32x32x16_bf16 v[192:207], v[88:91], v[32:35], v[192:207]
    ds_read_b128 v[84:87], v4 offset:49152
    s_waitcnt lgkmcnt(4)
    v_mfma_f32_32x32x16_bf16 v[192:207], v[92:95], v[36:39], v[192:207]
    ds_read_b128 v[88:91], v5 offset:49152
    s_waitcnt lgkmcnt(4)
    v_mfma_f32_32x32x16_bf16 v[192:207], v[96:99], v[40:43], v[192:207]
    ds_read_b128 v[92:95], v6 offset:49152
    s_waitcnt lgkmcnt(4)
    v_mfma_f32_32x32x16_bf16 v[192:207], v[100:103], v[44:47], v[192:207]
    ds_read_b128 v[96:99], v7 offset:49152
    s_waitcnt lgkmcnt(4)
    v_mfma_f32_32x32x16_bf16 v[208:223], v[80:83], v[16:19], 0
    ds_read_b128 v[100:103], v8 offset:49152
    s_waitcnt lgkmcnt(4)
    v_mfma_f32_32x32x16_bf16 v[208:223], v[84:87], v[20:23], v[208:223]
    ds_read_b128 v[80:83], v9 offset:49152
    s_waitcnt lgkmcnt(4)
    v_mfma_f32_32x32x16_bf16 v[208:223], v[88:91], v[24:27], v[208:223]
    ds_read_b128 v[84:87], v10 offset:49152
    s_waitcnt lgkmcnt(4)
    v_mfma_f32_32x32x16_bf16 v[208:223], v[92:95], v[28:31], v[208:223]
    ds_read_b128 v[88:91], v3 offset:57344
    s_waitcnt lgkmcnt(4)
    v_mfma_f32_32x32x16_bf16 v[208:223], v[96:99], v[32:35], v[208:223]
    ds_read_b128 v[92:95], v4 offset:57344
    s_waitcnt lgkmcnt(4)
    v_mfma_f32_32x32x16_bf16 v[208:223], v[100:103], v[36:39], v[208:223]
    ds_read_b128 v[96:99], v5 offset:57344
    s_waitcnt lgkmcnt(4)
    v_mfma_f32_32x32x16_bf16 v[208:223], v[80:83], v[40:43], v[208:223]
    ds_read_b128 v[100:103], v6 offset:57344
    s_waitcnt lgkmcnt(4)
    v_mfma_f32_32x32x16_bf16 v[208:223], v[84:87], v[44:47], v[208:223]
    ds_read_b128 v[80:83], v7 offset:57344
    s_waitcnt lgkmcnt(4)
    v_mfma_f32_32x32x16_bf16 v[224:239], v[88:91], v[16:19], 0
    ds_read_b128 v[84:87], v8 offset:57344
    s_waitcnt lgkmcnt(4)
    v_mfma_f32_32x32x16_bf16 v[224:239], v[92:95], v[20:23], v[224:239]
    ds_read_b128 v[88:91], v9 offset:57344
    s_waitcnt lgkmcnt(4)
    v_mfma_f32_32x32x16_bf16 v[224:239], v[96:99], v[24:27], v[224:239]
    ds_read_b128 v[92:95], v10 offset:57344
    s_waitcnt lgkmcnt(4)
    v_mfma_f32_32x32x16_bf16 v[224:239], v[100:103], v[28:31], v[224:239]
    s_waitcnt lgkmcnt(3)
    v_mfma_f32_32x32x16_bf16 v[224:239], v[80:83], v[32:35], v[224:239]
    s_waitcnt lgkmcnt(2)
    v_mfma_f32_32x32x16_bf16 v[224:239], v[84:87], v[36:39], v[224:239]
    s_waitcnt lgkmcnt(1)
    v_mfma_f32_32x32x16_bf16 v[224:239], v[88:91], v[40:43], v[224:239]
    s_waitcnt lgkmcnt(0)
    v_mfma_f32_32x32x16_bf16 v[224:239], v[92:95], v[44:47], v[224:239]
    s_add_u32 s34, s30, 16384
    buffer_load_dwordx4 v[16:19], v1, s[12:15], s34 offen offset:0
    buffer_load_dwordx4 v[20:23], v1, s[12:15], s34 offen offset:32
    buffer_load_dwordx4 v[24:27], v1, s[12:15], s34 offen offset:64
    buffer_load_dwordx4 v[28:31], v1, s[12:15], s34 offen offset:96
    buffer_load_dwordx4 v[32:35], v1, s[12:15], s34 offen offset:128
    buffer_load_dwordx4 v[36:39], v1, s[12:15], s34 offen offset:160
    buffer_load_dwordx4 v[40:43], v1, s[12:15], s34 offen offset:192
    buffer_load_dwordx4 v[44:47], v1, s[12:15], s34 offen offset:224
    s_nop 7
    v_max3_f32 v104, v112, v113, v114
    v_max3_f32 v106, v115, v116, v117
    v_max3_f32 v104, v104, v118, v119
    v_max3_f32 v106, v106, v120, v121
    v_max3_f32 v104, v104, v122, v123
    v_max3_f32 v106, v106, v124, v125
    v_max3_f32 v104, v104, v126, v127
    v_max3_f32 v106, v106, v128, v129
    v_max3_f32 v104, v104, v130, v131
    v_max3_f32 v106, v106, v132, v133
    v_max3_f32 v104, v104, v134, v135
    v_max3_f32 v106, v106, v136, v137
    v_max3_f32 v104, v104, v138, v139
    v_max3_f32 v106, v106, v140, v141
    v_max3_f32 v104, v104, v142, v143
    v_max3_f32 v106, v106, v144, v145
    v_max3_f32 v104, v104, v146, v147
    v_max3_f32 v106, v106, v148, v149
    v_max3_f32 v104, v104, v150, v151
    v_max3_f32 v106, v106, v152, v153
    v_max3_f32 v104, v104, v154, v155
    v_max3_f32 v106, v106, v156, v157
    v_max3_f32 v104, v104, v158, v159
    v_max3_f32 v106, v106, v160, v161
    v_max3_f32 v104, v104, v162, v163
    v_max3_f32 v106, v106, v164, v165
    v_max3_f32 v104, v104, v166, v167
    v_max3_f32 v106, v106, v168, v169
    v_max3_f32 v104, v104, v170, v171
    v_max3_f32 v106, v106, v172, v173
    v_max3_f32 v104, v104, v174, v175
    v_max3_f32 v106, v106, v176, v177
    v_max3_f32 v104, v104, v178, v179
    v_max3_f32 v106, v106, v180, v181
    v_max3_f32 v104, v104, v182, v183
    v_max3_f32 v106, v106, v184, v185
    v_max3_f32 v104, v104, v186, v187
    v_max3_f32 v106, v106, v188, v189
    v_max3_f32 v104, v104, v190, v191
    v_max3_f32 v106, v106, v192, v193
    v_max3_f32 v104, v104, v194, v195
    v_max3_f32 v106, v106, v196, v197
    v_max3_f32 v104, v104, v198, v199
    v_max3_f32 v106, v106, v200, v201
    v_max3_f32 v104, v104, v202, v203
    v_max3_f32 v106, v106, v204, v205
    v_max3_f32 v104, v104, v206, v207
    v_max3_f32 v106, v106, v208, v209
    v_max3_f32 v104, v104, v210, v211
    v_max3_f32 v106, v106, v212, v213
    v_max3_f32 v104, v104, v214, v215
    v_max3_f32 v106, v106, v216, v217
    v_max3_f32 v104, v104, v218, v219
    v_max3_f32 v106, v106, v220, v221
    v_max3_f32 v104, v104, v222, v223
    v_max3_f32 v106, v106, v224, v225
    v_max3_f32 v104, v104, v226, v227
    v_max3_f32 v106, v106, v228, v229
    v_max3_f32 v104, v104, v230, v231
    v_max3_f32 v106, v106, v232, v233
    v_max3_f32 v104, v104, v234, v235
    v_max3_f32 v106, v106, v236, v237
    v_max3_f32 v104, v104, v238, v239
    v_max_f32 v104, v104, v106
    v_mov_b32 v106, v104
    s_nop 1
    v_permlane32_swap_b32 v104, v106
    v_max_f32 v104, v104, v106
    v_mul_f32 v105, s32, v104
    v_mov_b32 v107, 0
    v_mov_b32 v108, 0
    v_mov_b32 v109, 0
    v_mov_b32 v110, 0
    v_fma_f32 v112, v112, s32, -v105
    v_fma_f32 v113, v113, s32, -v105
    v_fma_f32 v114, v114, s32, -v105
    v_fma_f32 v115, v115, s32, -v105
    v_exp_f32 v112, v112
    v_exp_f32 v113, v113
    v_exp_f32 v114, v114
    v_exp_f32 v115, v115
    s_nop 0
    v_add_f32 v107, v107, v112
    v_add_f32 v108, v108, v113
    v_add_f32 v109, v109, v114
    v_add_f32 v110, v110, v115
    v_cvt_pk_bf16_f32 v112, v112, v113
    v_cvt_pk_bf16_f32 v113, v114, v115
    v_fma_f32 v116, v116, s32, -v105
    v_fma_f32 v117, v117, s32, -v105
    v_fma_f32 v118, v118, s32, -v105
    v_fma_f32 v119, v119, s32, -v105
    v_exp_f32 v116, v116
    v_exp_f32 v117, v117
    v_exp_f32 v118, v118
    v_exp_f32 v119, v119
    s_nop 0
    v_add_f32 v107, v107, v116
    v_add_f32 v108, v108, v117
    v_add_f32 v109, v109, v118
    v_add_f32 v110, v110, v119
    v_cvt_pk_bf16_f32 v114, v116, v117
    v_cvt_pk_bf16_f32 v115, v118, v119
    v_fma_f32 v120, v120, s32, -v105
    v_fma_f32 v121, v121, s32, -v105
    v_fma_f32 v122, v122, s32, -v105
    v_fma_f32 v123, v123, s32, -v105
    v_exp_f32 v120, v120
    v_exp_f32 v121, v121
    v_exp_f32 v122, v122
    v_exp_f32 v123, v123
    s_nop 0
    v_add_f32 v107, v107, v120
    v_add_f32 v108, v108, v121
    v_add_f32 v109, v109, v122
    v_add_f32 v110, v110, v123
    v_cvt_pk_bf16_f32 v116, v120, v121
    v_cvt_pk_bf16_f32 v117, v122, v123
    v_fma_f32 v124, v124, s32, -v105
    v_fma_f32 v125, v125, s32, -v105
    v_fma_f32 v126, v126, s32, -v105
    v_fma_f32 v127, v127, s32, -v105
    v_exp_f32 v124, v124
    v_exp_f32 v125, v125
    v_exp_f32 v126, v126
    v_exp_f32 v127, v127
    s_nop 0
    v_add_f32 v107, v107, v124
    v_add_f32 v108, v108, v125
    v_add_f32 v109, v109, v126
    v_add_f32 v110, v110, v127
    v_cvt_pk_bf16_f32 v118, v124, v125
    v_cvt_pk_bf16_f32 v119, v126, v127
    v_fma_f32 v128, v128, s32, -v105
    v_fma_f32 v129, v129, s32, -v105
    v_fma_f32 v130, v130, s32, -v105
    v_fma_f32 v131, v131, s32, -v105
    v_exp_f32 v128, v128
    v_exp_f32 v129, v129
    v_exp_f32 v130, v130
    v_exp_f32 v131, v131
    s_nop 0
    v_add_f32 v107, v107, v128
    v_add_f32 v108, v108, v129
    v_add_f32 v109, v109, v130
    v_add_f32 v110, v110, v131
    v_cvt_pk_bf16_f32 v120, v128, v129
    v_cvt_pk_bf16_f32 v121, v130, v131
    v_fma_f32 v132, v132, s32, -v105
    v_fma_f32 v133, v133, s32, -v105
    v_fma_f32 v134, v134, s32, -v105
    v_fma_f32 v135, v135, s32, -v105
    v_exp_f32 v132, v132
    v_exp_f32 v133, v133
    v_exp_f32 v134, v134
    v_exp_f32 v135, v135
    s_nop 0
    v_add_f32 v107, v107, v132
    v_add_f32 v108, v108, v133
    v_add_f32 v109, v109, v134
    v_add_f32 v110, v110, v135
    v_cvt_pk_bf16_f32 v122, v132, v133
    v_cvt_pk_bf16_f32 v123, v134, v135
    v_fma_f32 v136, v136, s32, -v105
    v_fma_f32 v137, v137, s32, -v105
    v_fma_f32 v138, v138, s32, -v105
    v_fma_f32 v139, v139, s32, -v105
    v_exp_f32 v136, v136
    v_exp_f32 v137, v137
    v_exp_f32 v138, v138
    v_exp_f32 v139, v139
    s_nop 0
    v_add_f32 v107, v107, v136
    v_add_f32 v108, v108, v137
    v_add_f32 v109, v109, v138
    v_add_f32 v110, v110, v139
    v_cvt_pk_bf16_f32 v124, v136, v137
    v_cvt_pk_bf16_f32 v125, v138, v139
    v_fma_f32 v140, v140, s32, -v105
    v_fma_f32 v141, v141, s32, -v105
    v_fma_f32 v142, v142, s32, -v105
    v_fma_f32 v143, v143, s32, -v105
    v_exp_f32 v140, v140
    v_exp_f32 v141, v141
    v_exp_f32 v142, v142
    v_exp_f32 v143, v143
    s_nop 0
    v_add_f32 v107, v107, v140
    v_add_f32 v108, v108, v141
    v_add_f32 v109, v109, v142
    v_add_f32 v110, v110, v143
    v_cvt_pk_bf16_f32 v126, v140, v141
    v_cvt_pk_bf16_f32 v127, v142, v143
    v_fma_f32 v144, v144, s32, -v105
    v_fma_f32 v145, v145, s32, -v105
    v_fma_f32 v146, v146, s32, -v105
    v_fma_f32 v147, v147, s32, -v105
    v_exp_f32 v144, v144
    v_exp_f32 v145, v145
    v_exp_f32 v146, v146
    v_exp_f32 v147, v147
    s_nop 0
    v_add_f32 v107, v107, v144
    v_add_f32 v108, v108, v145
    v_add_f32 v109, v109, v146
    v_add_f32 v110, v110, v147
    v_cvt_pk_bf16_f32 v128, v144, v145
    v_cvt_pk_bf16_f32 v129, v146, v147
    v_fma_f32 v148, v148, s32, -v105
    v_fma_f32 v149, v149, s32, -v105
    v_fma_f32 v150, v150, s32, -v105
    v_fma_f32 v151, v151, s32, -v105
    v_exp_f32 v148, v148
    v_exp_f32 v149, v149
    v_exp_f32 v150, v150
    v_exp_f32 v151, v151
    s_nop 0
    v_add_f32 v107, v107, v148
    v_add_f32 v108, v108, v149
    v_add_f32 v109, v109, v150
    v_add_f32 v110, v110, v151
    v_cvt_pk_bf16_f32 v130, v148, v149
    v_cvt_pk_bf16_f32 v131, v150, v151
    v_fma_f32 v152, v152, s32, -v105
    v_fma_f32 v153, v153, s32, -v105
    v_fma_f32 v154, v154, s32, -v105
    v_fma_f32 v155, v155, s32, -v105
    v_exp_f32 v152, v152
    v_exp_f32 v153, v153
    v_exp_f32 v154, v154
    v_exp_f32 v155, v155
    s_nop 0
    v_add_f32 v107, v107, v152
    v_add_f32 v108, v108, v153
    v_add_f32 v109, v109, v154
    v_add_f32 v110, v110, v155
    v_cvt_pk_bf16_f32 v132, v152, v153
    v_cvt_pk_bf16_f32 v133, v154, v155
    v_fma_f32 v156, v156, s32, -v105
    v_fma_f32 v157, v157, s32, -v105
    v_fma_f32 v158, v158, s32, -v105
    v_fma_f32 v159, v159, s32, -v105
    v_exp_f32 v156, v156
    v_exp_f32 v157, v157
    v_exp_f32 v158, v158
    v_exp_f32 v159, v159
    s_nop 0
    v_add_f32 v107, v107, v156
    v_add_f32 v108, v108, v157
    v_add_f32 v109, v109, v158
    v_add_f32 v110, v110, v159
    v_cvt_pk_bf16_f32 v134, v156, v157
    v_cvt_pk_bf16_f32 v135, v158, v159
    v_fma_f32 v160, v160, s32, -v105
    v_fma_f32 v161, v161, s32, -v105
    v_fma_f32 v162, v162, s32, -v105
    v_fma_f32 v163, v163, s32, -v105
    v_exp_f32 v160, v160
    v_exp_f32 v161, v161
    v_exp_f32 v162, v162
    v_exp_f32 v163, v163
    s_nop 0
    v_add_f32 v107, v107, v160
    v_add_f32 v108, v108, v161
    v_add_f32 v109, v109, v162
    v_add_f32 v110, v110, v163
    v_cvt_pk_bf16_f32 v136, v160, v161
    v_cvt_pk_bf16_f32 v137, v162, v163
    v_fma_f32 v164, v164, s32, -v105
    v_fma_f32 v165, v165, s32, -v105
    v_fma_f32 v166, v166, s32, -v105
    v_fma_f32 v167, v167, s32, -v105
    v_exp_f32 v164, v164
    v_exp_f32 v165, v165
    v_exp_f32 v166, v166
    v_exp_f32 v167, v167
    s_nop 0
    v_add_f32 v107, v107, v164
    v_add_f32 v108, v108, v165
    v_add_f32 v109, v109, v166
    v_add_f32 v110, v110, v167
    v_cvt_pk_bf16_f32 v138, v164, v165
    v_cvt_pk_bf16_f32 v139, v166, v167
    v_fma_f32 v168, v168, s32, -v105
    v_fma_f32 v169, v169, s32, -v105
    v_fma_f32 v170, v170, s32, -v105
    v_fma_f32 v171, v171, s32, -v105
    v_exp_f32 v168, v168
    v_exp_f32 v169, v169
    v_exp_f32 v170, v170
    v_exp_f32 v171, v171
    s_nop 0
    v_add_f32 v107, v107, v168
    v_add_f32 v108, v108, v169
    v_add_f32 v109, v109, v170
    v_add_f32 v110, v110, v171
    v_cvt_pk_bf16_f32 v140, v168, v169
    v_cvt_pk_bf16_f32 v141, v170, v171
    v_fma_f32 v172, v172, s32, -v105
    v_fma_f32 v173, v173, s32, -v105
    v_fma_f32 v174, v174, s32, -v105
    v_fma_f32 v175, v175, s32, -v105
    v_exp_f32 v172, v172
    v_exp_f32 v173, v173
    v_exp_f32 v174, v174
    v_exp_f32 v175, v175
    s_nop 0
    v_add_f32 v107, v107, v172
    v_add_f32 v108, v108, v173
    v_add_f32 v109, v109, v174
    v_add_f32 v110, v110, v175
    v_cvt_pk_bf16_f32 v142, v172, v173
    v_cvt_pk_bf16_f32 v143, v174, v175
    v_fma_f32 v176, v176, s32, -v105
    v_fma_f32 v177, v177, s32, -v105
    v_fma_f32 v178, v178, s32, -v105
    v_fma_f32 v179, v179, s32, -v105
    v_exp_f32 v176, v176
    v_exp_f32 v177, v177
    v_exp_f32 v178, v178
    v_exp_f32 v179, v179
    s_nop 0
    v_add_f32 v107, v107, v176
    v_add_f32 v108, v108, v177
    v_add_f32 v109, v109, v178
    v_add_f32 v110, v110, v179
    v_cvt_pk_bf16_f32 v144, v176, v177
    v_cvt_pk_bf16_f32 v145, v178, v179
    v_fma_f32 v180, v180, s32, -v105
    v_fma_f32 v181, v181, s32, -v105
    v_fma_f32 v182, v182, s32, -v105
    v_fma_f32 v183, v183, s32, -v105
    v_exp_f32 v180, v180
    v_exp_f32 v181, v181
    v_exp_f32 v182, v182
    v_exp_f32 v183, v183
    s_nop 0
    v_add_f32 v107, v107, v180
    v_add_f32 v108, v108, v181
    v_add_f32 v109, v109, v182
    v_add_f32 v110, v110, v183
    v_cvt_pk_bf16_f32 v146, v180, v181
    v_cvt_pk_bf16_f32 v147, v182, v183
    v_fma_f32 v184, v184, s32, -v105
    v_fma_f32 v185, v185, s32, -v105
    v_fma_f32 v186, v186, s32, -v105
    v_fma_f32 v187, v187, s32, -v105
    v_exp_f32 v184, v184
    v_exp_f32 v185, v185
    v_exp_f32 v186, v186
    v_exp_f32 v187, v187
    s_nop 0
    v_add_f32 v107, v107, v184
    v_add_f32 v108, v108, v185
    v_add_f32 v109, v109, v186
    v_add_f32 v110, v110, v187
    v_cvt_pk_bf16_f32 v148, v184, v185
    v_cvt_pk_bf16_f32 v149, v186, v187
    v_fma_f32 v188, v188, s32, -v105
    v_fma_f32 v189, v189, s32, -v105
    v_fma_f32 v190, v190, s32, -v105
    v_fma_f32 v191, v191, s32, -v105
    v_exp_f32 v188, v188
    v_exp_f32 v189, v189
    v_exp_f32 v190, v190
    v_exp_f32 v191, v191
    s_nop 0
    v_add_f32 v107, v107, v188
    v_add_f32 v108, v108, v189
    v_add_f32 v109, v109, v190
    v_add_f32 v110, v110, v191
    v_cvt_pk_bf16_f32 v150, v188, v189
    v_cvt_pk_bf16_f32 v151, v190, v191
    v_fma_f32 v192, v192, s32, -v105
    v_fma_f32 v193, v193, s32, -v105
    v_fma_f32 v194, v194, s32, -v105
    v_fma_f32 v195, v195, s32, -v105
    v_exp_f32 v192, v192
    v_exp_f32 v193, v193
    v_exp_f32 v194, v194
    v_exp_f32 v195, v195
    s_nop 0
    v_add_f32 v107, v107, v192
    v_add_f32 v108, v108, v193
    v_add_f32 v109, v109, v194
    v_add_f32 v110, v110, v195
    v_cvt_pk_bf16_f32 v152, v192, v193
    v_cvt_pk_bf16_f32 v153, v194, v195
    v_fma_f32 v196, v196, s32, -v105
    v_fma_f32 v197, v197, s32, -v105
    v_fma_f32 v198, v198, s32, -v105
    v_fma_f32 v199, v199, s32, -v105
    v_exp_f32 v196, v196
    v_exp_f32 v197, v197
    v_exp_f32 v198, v198
    v_exp_f32 v199, v199
    s_nop 0
    v_add_f32 v107, v107, v196
    v_add_f32 v108, v108, v197
    v_add_f32 v109, v109, v198
    v_add_f32 v110, v110, v199
    v_cvt_pk_bf16_f32 v154, v196, v197
    v_cvt_pk_bf16_f32 v155, v198, v199
    v_fma_f32 v200, v200, s32, -v105
    v_fma_f32 v201, v201, s32, -v105
    v_fma_f32 v202, v202, s32, -v105
    v_fma_f32 v203, v203, s32, -v105
    v_exp_f32 v200, v200
    v_exp_f32 v201, v201
    v_exp_f32 v202, v202
    v_exp_f32 v203, v203
    s_nop 0
    v_add_f32 v107, v107, v200
    v_add_f32 v108, v108, v201
    v_add_f32 v109, v109, v202
    v_add_f32 v110, v110, v203
    v_cvt_pk_bf16_f32 v156, v200, v201
    v_cvt_pk_bf16_f32 v157, v202, v203
    v_fma_f32 v204, v204, s32, -v105
    v_fma_f32 v205, v205, s32, -v105
    v_fma_f32 v206, v206, s32, -v105
    v_fma_f32 v207, v207, s32, -v105
    v_exp_f32 v204, v204
    v_exp_f32 v205, v205
    v_exp_f32 v206, v206
    v_exp_f32 v207, v207
    s_nop 0
    v_add_f32 v107, v107, v204
    v_add_f32 v108, v108, v205
    v_add_f32 v109, v109, v206
    v_add_f32 v110, v110, v207
    v_cvt_pk_bf16_f32 v158, v204, v205
    v_cvt_pk_bf16_f32 v159, v206, v207
    v_fma_f32 v208, v208, s32, -v105
    v_fma_f32 v209, v209, s32, -v105
    v_fma_f32 v210, v210, s32, -v105
    v_fma_f32 v211, v211, s32, -v105
    v_exp_f32 v208, v208
    v_exp_f32 v209, v209
    v_exp_f32 v210, v210
    v_exp_f32 v211, v211
    s_nop 0
    v_add_f32 v107, v107, v208
    v_add_f32 v108, v108, v209
    v_add_f32 v109, v109, v210
    v_add_f32 v110, v110, v211
    v_cvt_pk_bf16_f32 v160, v208, v209
    v_cvt_pk_bf16_f32 v161, v210, v211
    v_fma_f32 v212, v212, s32, -v105
    v_fma_f32 v213, v213, s32, -v105
    v_fma_f32 v214, v214, s32, -v105
    v_fma_f32 v215, v215, s32, -v105
    v_exp_f32 v212, v212
    v_exp_f32 v213, v213
    v_exp_f32 v214, v214
    v_exp_f32 v215, v215
    s_nop 0
    v_add_f32 v107, v107, v212
    v_add_f32 v108, v108, v213
    v_add_f32 v109, v109, v214
    v_add_f32 v110, v110, v215
    v_cvt_pk_bf16_f32 v162, v212, v213
    v_cvt_pk_bf16_f32 v163, v214, v215
    v_fma_f32 v216, v216, s32, -v105
    v_fma_f32 v217, v217, s32, -v105
    v_fma_f32 v218, v218, s32, -v105
    v_fma_f32 v219, v219, s32, -v105
    v_exp_f32 v216, v216
    v_exp_f32 v217, v217
    v_exp_f32 v218, v218
    v_exp_f32 v219, v219
    s_nop 0
    v_add_f32 v107, v107, v216
    v_add_f32 v108, v108, v217
    v_add_f32 v109, v109, v218
    v_add_f32 v110, v110, v219
    v_cvt_pk_bf16_f32 v164, v216, v217
    v_cvt_pk_bf16_f32 v165, v218, v219
    v_fma_f32 v220, v220, s32, -v105
    v_fma_f32 v221, v221, s32, -v105
    v_fma_f32 v222, v222, s32, -v105
    v_fma_f32 v223, v223, s32, -v105
    v_exp_f32 v220, v220
    v_exp_f32 v221, v221
    v_exp_f32 v222, v222
    v_exp_f32 v223, v223
    s_nop 0
    v_add_f32 v107, v107, v220
    v_add_f32 v108, v108, v221
    v_add_f32 v109, v109, v222
    v_add_f32 v110, v110, v223
    v_cvt_pk_bf16_f32 v166, v220, v221
    v_cvt_pk_bf16_f32 v167, v222, v223
    v_fma_f32 v224, v224, s32, -v105
    v_fma_f32 v225, v225, s32, -v105
    v_fma_f32 v226, v226, s32, -v105
    v_fma_f32 v227, v227, s32, -v105
    v_exp_f32 v224, v224
    v_exp_f32 v225, v225
    v_exp_f32 v226, v226
    v_exp_f32 v227, v227
    s_nop 0
    v_add_f32 v107, v107, v224
    v_add_f32 v108, v108, v225
    v_add_f32 v109, v109, v226
    v_add_f32 v110, v110, v227
    v_cvt_pk_bf16_f32 v168, v224, v225
    v_cvt_pk_bf16_f32 v169, v226, v227
    v_fma_f32 v228, v228, s32, -v105
    v_fma_f32 v229, v229, s32, -v105
    v_fma_f32 v230, v230, s32, -v105
    v_fma_f32 v231, v231, s32, -v105
    v_exp_f32 v228, v228
    v_exp_f32 v229, v229
    v_exp_f32 v230, v230
    v_exp_f32 v231, v231
    s_nop 0
    v_add_f32 v107, v107, v228
    v_add_f32 v108, v108, v229
    v_add_f32 v109, v109, v230
    v_add_f32 v110, v110, v231
    v_cvt_pk_bf16_f32 v170, v228, v229
    v_cvt_pk_bf16_f32 v171, v230, v231
    v_fma_f32 v232, v232, s32, -v105
    v_fma_f32 v233, v233, s32, -v105
    v_fma_f32 v234, v234, s32, -v105
    v_fma_f32 v235, v235, s32, -v105
    v_exp_f32 v232, v232
    v_exp_f32 v233, v233
    v_exp_f32 v234, v234
    v_exp_f32 v235, v235
    s_nop 0
    v_add_f32 v107, v107, v232
    v_add_f32 v108, v108, v233
    v_add_f32 v109, v109, v234
    v_add_f32 v110, v110, v235
    v_cvt_pk_bf16_f32 v172, v232, v233
    v_cvt_pk_bf16_f32 v173, v234, v235
    v_fma_f32 v236, v236, s32, -v105
    v_fma_f32 v237, v237, s32, -v105
    v_fma_f32 v238, v238, s32, -v105
    v_fma_f32 v239, v239, s32, -v105
    v_exp_f32 v236, v236
    v_exp_f32 v237, v237
    v_exp_f32 v238, v238
    v_exp_f32 v239, v239
    s_nop 0
    v_add_f32 v107, v107, v236
    v_add_f32 v108, v108, v237
    v_add_f32 v109, v109, v238
    v_add_f32 v110, v110, v239
    v_cvt_pk_bf16_f32 v174, v236, v237
    v_cvt_pk_bf16_f32 v175, v238, v239
    v_add_f32 v107, v107, v108
    v_add_f32 v109, v109, v110
    v_add_f32 v107, v107, v109
    v_mov_b32 v106, v107
    s_nop 1
    v_permlane32_swap_b32 v107, v106
    v_add_f32 v107, v107, v106
    v_rcp_f32 v111, v107
    s_waitcnt vmcnt(16)
    s_barrier
    ds_read_b64_tr_b16 v[80:81], v11 offset:0
    ds_read_b64_tr_b16 v[82:83], v11 offset:2048
    ds_read_b64_tr_b16 v[84:85], v12 offset:0
    ds_read_b64_tr_b16 v[86:87], v12 offset:2048
    ds_read_b64_tr_b16 v[88:89], v13 offset:0
    ds_read_b64_tr_b16 v[90:91], v13 offset:2048
    ds_read_b64_tr_b16 v[92:93], v14 offset:0
    ds_read_b64_tr_b16 v[94:95], v14 offset:2048
    ds_read_b64_tr_b16 v[96:97], v11 offset:4096
    ds_read_b64_tr_b16 v[98:99], v11 offset:6144
    s_waitcnt lgkmcnt(8)
    v_mfma_f32_32x32x16_bf16 v[176:191], v[80:83], v[112:115], 0
    ds_read_b64_tr_b16 v[100:101], v12 offset:4096
    ds_read_b64_tr_b16 v[102:103], v12 offset:6144
    s_waitcnt lgkmcnt(8)
    v_mfma_f32_32x32x16_bf16 v[192:207], v[84:87], v[112:115], 0
    ds_read_b64_tr_b16 v[80:81], v13 offset:4096
    ds_read_b64_tr_b16 v[82:83], v13 offset:6144
    s_waitcnt lgkmcnt(8)
    v_mfma_f32_32x32x16_bf16 v[208:223], v[88:91], v[112:115], 0
    ds_read_b64_tr_b16 v[84:85], v14 offset:4096
    ds_read_b64_tr_b16 v[86:87], v14 offset:6144
    s_waitcnt lgkmcnt(8)
    v_mfma_f32_32x32x16_bf16 v[224:239], v[92:95], v[112:115], 0
    ds_read_b64_tr_b16 v[88:89], v11 offset:8192
    ds_read_b64_tr_b16 v[90:91], v11 offset:10240
    s_waitcnt lgkmcnt(8)
    v_mfma_f32_32x32x16_bf16 v[176:191], v[96:99], v[116:119], v[176:191]
    ds_read_b64_tr_b16 v[92:93], v12 offset:8192
    ds_read_b64_tr_b16 v[94:95], v12 offset:10240
    s_waitcnt lgkmcnt(8)
    v_mfma_f32_32x32x16_bf16 v[192:207], v[100:103], v[116:119], v[192:207]
    ds_read_b64_tr_b16 v[96:97], v13 offset:8192
    ds_read_b64_tr_b16 v[98:99], v13 offset:10240
    s_waitcnt lgkmcnt(8)
    v_mfma_f32_32x32x16_bf16 v[208:223], v[80:83], v[116:119], v[208:223]
    ds_read_b64_tr_b16 v[100:101], v14 offset:8192
    ds_read_b64_tr_b16 v[102:103], v14 offset:10240
    s_waitcnt lgkmcnt(8)
    v_mfma_f32_32x32x16_bf16 v[224:239], v[84:87], v[116:119], v[224:239]
    ds_read_b64_tr_b16 v[80:81], v11 offset:12288
    ds_read_b64_tr_b16 v[82:83], v11 offset:14336
    s_waitcnt lgkmcnt(8)
    v_mfma_f32_32x32x16_bf16 v[176:191], v[88:91], v[120:123], v[176:191]
    ds_read_b64_tr_b16 v[84:85], v12 offset:12288
    ds_read_b64_tr_b16 v[86:87], v12 offset:14336
    s_waitcnt lgkmcnt(8)
    v_mfma_f32_32x32x16_bf16 v[192:207], v[92:95], v[120:123], v[192:207]
    ds_read_b64_tr_b16 v[88:89], v13 offset:12288
    ds_read_b64_tr_b16 v[90:91], v13 offset:14336
    s_waitcnt lgkmcnt(8)
    v_mfma_f32_32x32x16_bf16 v[208:223], v[96:99], v[120:123], v[208:223]
    ds_read_b64_tr_b16 v[92:93], v14 offset:12288
    ds_read_b64_tr_b16 v[94:95], v14 offset:14336
    s_waitcnt lgkmcnt(8)
    v_mfma_f32_32x32x16_bf16 v[224:239], v[100:103], v[120:123], v[224:239]
    ds_read_b64_tr_b16 v[96:97], v11 offset:16384
    ds_read_b64_tr_b16 v[98:99], v11 offset:18432
    s_waitcnt lgkmcnt(8)
    v_mfma_f32_32x32x16_bf16 v[176:191], v[80:83], v[124:127], v[176:191]
    ds_read_b64_tr_b16 v[100:101], v12 offset:16384
    ds_read_b64_tr_b16 v[102:103], v12 offset:18432
    s_waitcnt lgkmcnt(8)
    v_mfma_f32_32x32x16_bf16 v[192:207], v[84:87], v[124:127], v[192:207]
    ds_read_b64_tr_b16 v[80:81], v13 offset:16384
    ds_read_b64_tr_b16 v[82:83], v13 offset:18432
    s_waitcnt lgkmcnt(8)
    v_mfma_f32_32x32x16_bf16 v[208:223], v[88:91], v[124:127], v[208:223]
    ds_read_b64_tr_b16 v[84:85], v14 offset:16384
    ds_read_b64_tr_b16 v[86:87], v14 offset:18432
    s_waitcnt lgkmcnt(8)
    v_mfma_f32_32x32x16_bf16 v[224:239], v[92:95], v[124:127], v[224:239]
    ds_read_b64_tr_b16 v[88:89], v11 offset:20480
    ds_read_b64_tr_b16 v[90:91], v11 offset:22528
    s_waitcnt lgkmcnt(8)
    v_mfma_f32_32x32x16_bf16 v[176:191], v[96:99], v[128:131], v[176:191]
    ds_read_b64_tr_b16 v[92:93], v12 offset:20480
    ds_read_b64_tr_b16 v[94:95], v12 offset:22528
    s_waitcnt lgkmcnt(8)
    v_mfma_f32_32x32x16_bf16 v[192:207], v[100:103], v[128:131], v[192:207]
    ds_read_b64_tr_b16 v[96:97], v13 offset:20480
    ds_read_b64_tr_b16 v[98:99], v13 offset:22528
    s_waitcnt lgkmcnt(8)
    v_mfma_f32_32x32x16_bf16 v[208:223], v[80:83], v[128:131], v[208:223]
    ds_read_b64_tr_b16 v[100:101], v14 offset:20480
    ds_read_b64_tr_b16 v[102:103], v14 offset:22528
    s_waitcnt lgkmcnt(8)
    v_mfma_f32_32x32x16_bf16 v[224:239], v[84:87], v[128:131], v[224:239]
    ds_read_b64_tr_b16 v[80:81], v11 offset:24576
    ds_read_b64_tr_b16 v[82:83], v11 offset:26624
    s_waitcnt lgkmcnt(8)
    v_mfma_f32_32x32x16_bf16 v[176:191], v[88:91], v[132:135], v[176:191]
    ds_read_b64_tr_b16 v[84:85], v12 offset:24576
    ds_read_b64_tr_b16 v[86:87], v12 offset:26624
    s_waitcnt lgkmcnt(8)
    v_mfma_f32_32x32x16_bf16 v[192:207], v[92:95], v[132:135], v[192:207]
    ds_read_b64_tr_b16 v[88:89], v13 offset:24576
    ds_read_b64_tr_b16 v[90:91], v13 offset:26624
    s_waitcnt lgkmcnt(8)
    v_mfma_f32_32x32x16_bf16 v[208:223], v[96:99], v[132:135], v[208:223]
    ds_read_b64_tr_b16 v[92:93], v14 offset:24576
    ds_read_b64_tr_b16 v[94:95], v14 offset:26624
    s_waitcnt lgkmcnt(8)
    v_mfma_f32_32x32x16_bf16 v[224:239], v[100:103], v[132:135], v[224:239]
    ds_read_b64_tr_b16 v[96:97], v11 offset:28672
    ds_read_b64_tr_b16 v[98:99], v11 offset:30720
    s_waitcnt lgkmcnt(8)
    v_mfma_f32_32x32x16_bf16 v[176:191], v[80:83], v[136:139], v[176:191]
    ds_read_b64_tr_b16 v[100:101], v12 offset:28672
    ds_read_b64_tr_b16 v[102:103], v12 offset:30720
    s_waitcnt lgkmcnt(8)
    v_mfma_f32_32x32x16_bf16 v[192:207], v[84:87], v[136:139], v[192:207]
    ds_read_b64_tr_b16 v[80:81], v13 offset:28672
    ds_read_b64_tr_b16 v[82:83], v13 offset:30720
    s_waitcnt lgkmcnt(8)
    v_mfma_f32_32x32x16_bf16 v[208:223], v[88:91], v[136:139], v[208:223]
    ds_read_b64_tr_b16 v[84:85], v14 offset:28672
    ds_read_b64_tr_b16 v[86:87], v14 offset:30720
    s_waitcnt lgkmcnt(8)
    v_mfma_f32_32x32x16_bf16 v[224:239], v[92:95], v[136:139], v[224:239]
    ds_read_b64_tr_b16 v[88:89], v11 offset:32768
    ds_read_b64_tr_b16 v[90:91], v11 offset:34816
    s_waitcnt lgkmcnt(8)
    v_mfma_f32_32x32x16_bf16 v[176:191], v[96:99], v[140:143], v[176:191]
    ds_read_b64_tr_b16 v[92:93], v12 offset:32768
    ds_read_b64_tr_b16 v[94:95], v12 offset:34816
    s_waitcnt lgkmcnt(8)
    v_mfma_f32_32x32x16_bf16 v[192:207], v[100:103], v[140:143], v[192:207]
    ds_read_b64_tr_b16 v[96:97], v13 offset:32768
    ds_read_b64_tr_b16 v[98:99], v13 offset:34816
    s_waitcnt lgkmcnt(8)
    v_mfma_f32_32x32x16_bf16 v[208:223], v[80:83], v[140:143], v[208:223]
    ds_read_b64_tr_b16 v[100:101], v14 offset:32768
    ds_read_b64_tr_b16 v[102:103], v14 offset:34816
    s_waitcnt lgkmcnt(8)
    v_mfma_f32_32x32x16_bf16 v[224:239], v[84:87], v[140:143], v[224:239]
    ds_read_b64_tr_b16 v[80:81], v11 offset:36864
    ds_read_b64_tr_b16 v[82:83], v11 offset:38912
    s_waitcnt lgkmcnt(8)
    v_mfma_f32_32x32x16_bf16 v[176:191], v[88:91], v[144:147], v[176:191]
    ds_read_b64_tr_b16 v[84:85], v12 offset:36864
    ds_read_b64_tr_b16 v[86:87], v12 offset:38912
    s_waitcnt lgkmcnt(8)
    v_mfma_f32_32x32x16_bf16 v[192:207], v[92:95], v[144:147], v[192:207]
    ds_read_b64_tr_b16 v[88:89], v13 offset:36864
    ds_read_b64_tr_b16 v[90:91], v13 offset:38912
    s_waitcnt lgkmcnt(8)
    v_mfma_f32_32x32x16_bf16 v[208:223], v[96:99], v[144:147], v[208:223]
    ds_read_b64_tr_b16 v[92:93], v14 offset:36864
    ds_read_b64_tr_b16 v[94:95], v14 offset:38912
    s_waitcnt lgkmcnt(8)
    v_mfma_f32_32x32x16_bf16 v[224:239], v[100:103], v[144:147], v[224:239]
    ds_read_b64_tr_b16 v[96:97], v11 offset:40960
    ds_read_b64_tr_b16 v[98:99], v11 offset:43008
    s_waitcnt lgkmcnt(8)
    v_mfma_f32_32x32x16_bf16 v[176:191], v[80:83], v[148:151], v[176:191]
    ds_read_b64_tr_b16 v[100:101], v12 offset:40960
    ds_read_b64_tr_b16 v[102:103], v12 offset:43008
    s_waitcnt lgkmcnt(8)
    v_mfma_f32_32x32x16_bf16 v[192:207], v[84:87], v[148:151], v[192:207]
    ds_read_b64_tr_b16 v[80:81], v13 offset:40960
    ds_read_b64_tr_b16 v[82:83], v13 offset:43008
    s_waitcnt lgkmcnt(8)
    v_mfma_f32_32x32x16_bf16 v[208:223], v[88:91], v[148:151], v[208:223]
    ds_read_b64_tr_b16 v[84:85], v14 offset:40960
    ds_read_b64_tr_b16 v[86:87], v14 offset:43008
    s_waitcnt lgkmcnt(8)
    v_mfma_f32_32x32x16_bf16 v[224:239], v[92:95], v[148:151], v[224:239]
    ds_read_b64_tr_b16 v[88:89], v11 offset:45056
    ds_read_b64_tr_b16 v[90:91], v11 offset:47104
    s_waitcnt lgkmcnt(8)
    v_mfma_f32_32x32x16_bf16 v[176:191], v[96:99], v[152:155], v[176:191]
    ds_read_b64_tr_b16 v[92:93], v12 offset:45056
    ds_read_b64_tr_b16 v[94:95], v12 offset:47104
    s_waitcnt lgkmcnt(8)
    v_mfma_f32_32x32x16_bf16 v[192:207], v[100:103], v[152:155], v[192:207]
    ds_read_b64_tr_b16 v[96:97], v13 offset:45056
    ds_read_b64_tr_b16 v[98:99], v13 offset:47104
    s_waitcnt lgkmcnt(8)
    v_mfma_f32_32x32x16_bf16 v[208:223], v[80:83], v[152:155], v[208:223]
    ds_read_b64_tr_b16 v[100:101], v14 offset:45056
    ds_read_b64_tr_b16 v[102:103], v14 offset:47104
    s_waitcnt lgkmcnt(8)
    v_mfma_f32_32x32x16_bf16 v[224:239], v[84:87], v[152:155], v[224:239]
    ds_read_b64_tr_b16 v[80:81], v11 offset:49152
    ds_read_b64_tr_b16 v[82:83], v11 offset:51200
    s_waitcnt lgkmcnt(8)
    v_mfma_f32_32x32x16_bf16 v[176:191], v[88:91], v[156:159], v[176:191]
    ds_read_b64_tr_b16 v[84:85], v12 offset:49152
    ds_read_b64_tr_b16 v[86:87], v12 offset:51200
    s_waitcnt lgkmcnt(8)
    v_mfma_f32_32x32x16_bf16 v[192:207], v[92:95], v[156:159], v[192:207]
    ds_read_b64_tr_b16 v[88:89], v13 offset:49152
    ds_read_b64_tr_b16 v[90:91], v13 offset:51200
    s_waitcnt lgkmcnt(8)
    v_mfma_f32_32x32x16_bf16 v[208:223], v[96:99], v[156:159], v[208:223]
    ds_read_b64_tr_b16 v[92:93], v14 offset:49152
    ds_read_b64_tr_b16 v[94:95], v14 offset:51200
    s_waitcnt lgkmcnt(8)
    v_mfma_f32_32x32x16_bf16 v[224:239], v[100:103], v[156:159], v[224:239]
    ds_read_b64_tr_b16 v[96:97], v11 offset:53248
    ds_read_b64_tr_b16 v[98:99], v11 offset:55296
    s_waitcnt lgkmcnt(8)
    v_mfma_f32_32x32x16_bf16 v[176:191], v[80:83], v[160:163], v[176:191]
    ds_read_b64_tr_b16 v[100:101], v12 offset:53248
    ds_read_b64_tr_b16 v[102:103], v12 offset:55296
    s_waitcnt lgkmcnt(8)
    v_mfma_f32_32x32x16_bf16 v[192:207], v[84:87], v[160:163], v[192:207]
    ds_read_b64_tr_b16 v[80:81], v13 offset:53248
    ds_read_b64_tr_b16 v[82:83], v13 offset:55296
    s_waitcnt lgkmcnt(8)
    v_mfma_f32_32x32x16_bf16 v[208:223], v[88:91], v[160:163], v[208:223]
    ds_read_b64_tr_b16 v[84:85], v14 offset:53248
    ds_read_b64_tr_b16 v[86:87], v14 offset:55296
    s_waitcnt lgkmcnt(8)
    v_mfma_f32_32x32x16_bf16 v[224:239], v[92:95], v[160:163], v[224:239]
    ds_read_b64_tr_b16 v[88:89], v11 offset:57344
    ds_read_b64_tr_b16 v[90:91], v11 offset:59392
    s_waitcnt lgkmcnt(8)
    v_mfma_f32_32x32x16_bf16 v[176:191], v[96:99], v[164:167], v[176:191]
    ds_read_b64_tr_b16 v[92:93], v12 offset:57344
    ds_read_b64_tr_b16 v[94:95], v12 offset:59392
    s_waitcnt lgkmcnt(8)
    v_mfma_f32_32x32x16_bf16 v[192:207], v[100:103], v[164:167], v[192:207]
    ds_read_b64_tr_b16 v[96:97], v13 offset:57344
    ds_read_b64_tr_b16 v[98:99], v13 offset:59392
    s_waitcnt lgkmcnt(8)
    v_mfma_f32_32x32x16_bf16 v[208:223], v[80:83], v[164:167], v[208:223]
    ds_read_b64_tr_b16 v[100:101], v14 offset:57344
    ds_read_b64_tr_b16 v[102:103], v14 offset:59392
    s_waitcnt lgkmcnt(8)
    v_mfma_f32_32x32x16_bf16 v[224:239], v[84:87], v[164:167], v[224:239]
    ds_read_b64_tr_b16 v[80:81], v11 offset:61440
    ds_read_b64_tr_b16 v[82:83], v11 offset:63488
    s_waitcnt lgkmcnt(8)
    v_mfma_f32_32x32x16_bf16 v[176:191], v[88:91], v[168:171], v[176:191]
    ds_read_b64_tr_b16 v[84:85], v12 offset:61440
    ds_read_b64_tr_b16 v[86:87], v12 offset:63488
    s_waitcnt lgkmcnt(8)
    v_mfma_f32_32x32x16_bf16 v[192:207], v[92:95], v[168:171], v[192:207]
    ds_read_b64_tr_b16 v[88:89], v13 offset:61440
    ds_read_b64_tr_b16 v[90:91], v13 offset:63488
    s_waitcnt lgkmcnt(8)
    v_mfma_f32_32x32x16_bf16 v[208:223], v[96:99], v[168:171], v[208:223]
    ds_read_b64_tr_b16 v[92:93], v14 offset:61440
    ds_read_b64_tr_b16 v[94:95], v14 offset:63488
    s_waitcnt lgkmcnt(8)
    v_mfma_f32_32x32x16_bf16 v[224:239], v[100:103], v[168:171], v[224:239]
    s_waitcnt lgkmcnt(6)
    v_mfma_f32_32x32x16_bf16 v[176:191], v[80:83], v[172:175], v[176:191]
    s_waitcnt lgkmcnt(4)
    v_mfma_f32_32x32x16_bf16 v[192:207], v[84:87], v[172:175], v[192:207]
    s_waitcnt lgkmcnt(2)
    v_mfma_f32_32x32x16_bf16 v[208:223], v[88:91], v[172:175], v[208:223]
    s_waitcnt lgkmcnt(0)
    v_mfma_f32_32x32x16_bf16 v[224:239], v[92:95], v[172:175], v[224:239]
    s_nop 7
    s_nop 7
    s_add_u32 s38, s30, 0
    s_add_u32 s39, s30, 4096
    v_mul_f32 v176, v176, v111
    v_mul_f32 v177, v177, v111
    v_mul_f32 v178, v178, v111
    v_mul_f32 v179, v179, v111
    v_mul_f32 v180, v180, v111
    v_mul_f32 v181, v181, v111
    v_mul_f32 v182, v182, v111
    v_mul_f32 v183, v183, v111
    v_mul_f32 v184, v184, v111
    v_mul_f32 v185, v185, v111
    v_mul_f32 v186, v186, v111
    v_mul_f32 v187, v187, v111
    v_mul_f32 v188, v188, v111
    v_mul_f32 v189, v189, v111
    v_mul_f32 v190, v190, v111
    v_mul_f32 v191, v191, v111
    v_cvt_pk_bf16_f32 v176, v176, v177
    v_cvt_pk_bf16_f32 v177, v178, v179
    v_cvt_pk_bf16_f32 v178, v180, v181
    v_cvt_pk_bf16_f32 v179, v182, v183
    v_cvt_pk_bf16_f32 v180, v184, v185
    v_cvt_pk_bf16_f32 v181, v186, v187
    v_cvt_pk_bf16_f32 v182, v188, v189
    v_cvt_pk_bf16_f32 v183, v190, v191
    ds_write_b128 v240, v[176:179]
    ds_write_b128 v241, v[180:183]
    v_mul_f32 v192, v192, v111
    v_mul_f32 v193, v193, v111
    v_mul_f32 v194, v194, v111
    v_mul_f32 v195, v195, v111
    v_mul_f32 v196, v196, v111
    v_mul_f32 v197, v197, v111
    v_mul_f32 v198, v198, v111
    v_mul_f32 v199, v199, v111
    v_mul_f32 v200, v200, v111
    v_mul_f32 v201, v201, v111
    v_mul_f32 v202, v202, v111
    v_mul_f32 v203, v203, v111
    v_mul_f32 v204, v204, v111
    v_mul_f32 v205, v205, v111
    v_mul_f32 v206, v206, v111
    v_mul_f32 v207, v207, v111
    v_cvt_pk_bf16_f32 v192, v192, v193
    v_cvt_pk_bf16_f32 v193, v194, v195
    v_cvt_pk_bf16_f32 v194, v196, v197
    v_cvt_pk_bf16_f32 v195, v198, v199
    v_cvt_pk_bf16_f32 v196, v200, v201
    v_cvt_pk_bf16_f32 v197, v202, v203
    v_cvt_pk_bf16_f32 v198, v204, v205
    v_cvt_pk_bf16_f32 v199, v206, v207
    ds_write_b128 v242, v[192:195]
    ds_write_b128 v243, v[196:199]
    s_waitcnt lgkmcnt(0)
    ds_read_b128 v[80:83], v2 offset:0
    ds_read_b128 v[84:87], v2 offset:1024
    ds_read_b128 v[88:91], v2 offset:2048
    ds_read_b128 v[92:95], v2 offset:3072
    s_waitcnt lgkmcnt(3)
    buffer_store_dwordx4 v[80:83], v244, s[24:27], s38 offen offset:0
    s_waitcnt lgkmcnt(2)
    buffer_store_dwordx4 v[84:87], v244, s[24:27], s38 offen offset:2048
    s_waitcnt lgkmcnt(1)
    buffer_store_dwordx4 v[88:91], v244, s[24:27], s39 offen offset:0
    s_waitcnt lgkmcnt(0)
    buffer_store_dwordx4 v[92:95], v244, s[24:27], s39 offen offset:2048
    v_mul_f32 v208, v208, v111
    v_mul_f32 v209, v209, v111
    v_mul_f32 v210, v210, v111
    v_mul_f32 v211, v211, v111
    v_mul_f32 v212, v212, v111
    v_mul_f32 v213, v213, v111
    v_mul_f32 v214, v214, v111
    v_mul_f32 v215, v215, v111
    v_mul_f32 v216, v216, v111
    v_mul_f32 v217, v217, v111
    v_mul_f32 v218, v218, v111
    v_mul_f32 v219, v219, v111
    v_mul_f32 v220, v220, v111
    v_mul_f32 v221, v221, v111
    v_mul_f32 v222, v222, v111
    v_mul_f32 v223, v223, v111
    v_cvt_pk_bf16_f32 v208, v208, v209
    v_cvt_pk_bf16_f32 v209, v210, v211
    v_cvt_pk_bf16_f32 v210, v212, v213
    v_cvt_pk_bf16_f32 v211, v214, v215
    v_cvt_pk_bf16_f32 v212, v216, v217
    v_cvt_pk_bf16_f32 v213, v218, v219
    v_cvt_pk_bf16_f32 v214, v220, v221
    v_cvt_pk_bf16_f32 v215, v222, v223
    ds_write_b128 v240, v[208:211]
    ds_write_b128 v241, v[212:215]
    v_mul_f32 v224, v224, v111
    v_mul_f32 v225, v225, v111
    v_mul_f32 v226, v226, v111
    v_mul_f32 v227, v227, v111
    v_mul_f32 v228, v228, v111
    v_mul_f32 v229, v229, v111
    v_mul_f32 v230, v230, v111
    v_mul_f32 v231, v231, v111
    v_mul_f32 v232, v232, v111
    v_mul_f32 v233, v233, v111
    v_mul_f32 v234, v234, v111
    v_mul_f32 v235, v235, v111
    v_mul_f32 v236, v236, v111
    v_mul_f32 v237, v237, v111
    v_mul_f32 v238, v238, v111
    v_mul_f32 v239, v239, v111
    v_cvt_pk_bf16_f32 v224, v224, v225
    v_cvt_pk_bf16_f32 v225, v226, v227
    v_cvt_pk_bf16_f32 v226, v228, v229
    v_cvt_pk_bf16_f32 v227, v230, v231
    v_cvt_pk_bf16_f32 v228, v232, v233
    v_cvt_pk_bf16_f32 v229, v234, v235
    v_cvt_pk_bf16_f32 v230, v236, v237
    v_cvt_pk_bf16_f32 v231, v238, v239
    ds_write_b128 v242, v[224:227]
    ds_write_b128 v243, v[228:231]
    s_waitcnt lgkmcnt(0)
    ds_read_b128 v[80:83], v2 offset:0
    ds_read_b128 v[84:87], v2 offset:1024
    ds_read_b128 v[88:91], v2 offset:2048
    ds_read_b128 v[92:95], v2 offset:3072
    s_waitcnt lgkmcnt(3)
    buffer_store_dwordx4 v[80:83], v244, s[24:27], s38 offen offset:128
    s_waitcnt lgkmcnt(2)
    buffer_store_dwordx4 v[84:87], v244, s[24:27], s38 offen offset:2176
    s_waitcnt lgkmcnt(1)
    buffer_store_dwordx4 v[88:91], v244, s[24:27], s39 offen offset:128
    s_waitcnt lgkmcnt(0)
    buffer_store_dwordx4 v[92:95], v244, s[24:27], s39 offen offset:2176
    s_waitcnt vmcnt(16)
    ds_read_b128 v[80:83], v3 offset:0
    ds_read_b128 v[84:87], v4 offset:0
    ds_read_b128 v[88:91], v5 offset:0
    ds_read_b128 v[92:95], v6 offset:0
    ds_read_b128 v[96:99], v7 offset:0
    s_waitcnt lgkmcnt(4)
    v_mfma_f32_32x32x16_bf16 v[112:127], v[80:83], v[48:51], 0
    ds_read_b128 v[100:103], v8 offset:0
    s_waitcnt lgkmcnt(4)
    v_mfma_f32_32x32x16_bf16 v[112:127], v[84:87], v[52:55], v[112:127]
    ds_read_b128 v[80:83], v9 offset:0
    s_waitcnt lgkmcnt(4)
    v_mfma_f32_32x32x16_bf16 v[112:127], v[88:91], v[56:59], v[112:127]
    ds_read_b128 v[84:87], v10 offset:0
    s_waitcnt lgkmcnt(4)
    v_mfma_f32_32x32x16_bf16 v[112:127], v[92:95], v[60:63], v[112:127]
    ds_read_b128 v[88:91], v3 offset:8192
    s_waitcnt lgkmcnt(4)
    v_mfma_f32_32x32x16_bf16 v[112:127], v[96:99], v[64:67], v[112:127]
    ds_read_b128 v[92:95], v4 offset:8192
    s_waitcnt lgkmcnt(4)
    v_mfma_f32_32x32x16_bf16 v[112:127], v[100:103], v[68:71], v[112:127]
    ds_read_b128 v[96:99], v5 offset:8192
    s_waitcnt lgkmcnt(4)
    v_mfma_f32_32x32x16_bf16 v[112:127], v[80:83], v[72:75], v[112:127]
    ds_read_b128 v[100:103], v6 offset:8192
    s_waitcnt lgkmcnt(4)
    v_mfma_f32_32x32x16_bf16 v[112:127], v[84:87], v[76:79], v[112:127]
    ds_read_b128 v[80:83], v7 offset:8192
    s_waitcnt lgkmcnt(4)
    v_mfma_f32_32x32x16_bf16 v[128:143], v[88:91], v[48:51], 0
    ds_read_b128 v[84:87], v8 offset:8192
    s_waitcnt lgkmcnt(4)
    v_mfma_f32_32x32x16_bf16 v[128:143], v[92:95], v[52:55], v[128:143]
    ds_read_b128 v[88:91], v9 offset:8192
    s_waitcnt lgkmcnt(4)
    v_mfma_f32_32x32x16_bf16 v[128:143], v[96:99], v[56:59], v[128:143]
    ds_read_b128 v[92:95], v10 offset:8192
    s_waitcnt lgkmcnt(4)
    v_mfma_f32_32x32x16_bf16 v[128:143], v[100:103], v[60:63], v[128:143]
    ds_read_b128 v[96:99], v3 offset:16384
    s_waitcnt lgkmcnt(4)
    v_mfma_f32_32x32x16_bf16 v[128:143], v[80:83], v[64:67], v[128:143]
    ds_read_b128 v[100:103], v4 offset:16384
    s_waitcnt lgkmcnt(4)
    v_mfma_f32_32x32x16_bf16 v[128:143], v[84:87], v[68:71], v[128:143]
    ds_read_b128 v[80:83], v5 offset:16384
    s_waitcnt lgkmcnt(4)
    v_mfma_f32_32x32x16_bf16 v[128:143], v[88:91], v[72:75], v[128:143]
    ds_read_b128 v[84:87], v6 offset:16384
    s_waitcnt lgkmcnt(4)
    v_mfma_f32_32x32x16_bf16 v[128:143], v[92:95], v[76:79], v[128:143]
    ds_read_b128 v[88:91], v7 offset:16384
    s_waitcnt lgkmcnt(4)
    v_mfma_f32_32x32x16_bf16 v[144:159], v[96:99], v[48:51], 0
    ds_read_b128 v[92:95], v8 offset:16384
    s_waitcnt lgkmcnt(4)
    v_mfma_f32_32x32x16_bf16 v[144:159], v[100:103], v[52:55], v[144:159]
    ds_read_b128 v[96:99], v9 offset:16384
    s_waitcnt lgkmcnt(4)
    v_mfma_f32_32x32x16_bf16 v[144:159], v[80:83], v[56:59], v[144:159]
    ds_read_b128 v[100:103], v10 offset:16384
    s_waitcnt lgkmcnt(4)
    v_mfma_f32_32x32x16_bf16 v[144:159], v[84:87], v[60:63], v[144:159]
    ds_read_b128 v[80:83], v3 offset:24576
    s_waitcnt lgkmcnt(4)
    v_mfma_f32_32x32x16_bf16 v[144:159], v[88:91], v[64:67], v[144:159]
    ds_read_b128 v[84:87], v4 offset:24576
    s_waitcnt lgkmcnt(4)
    v_mfma_f32_32x32x16_bf16 v[144:159], v[92:95], v[68:71], v[144:159]
    ds_read_b128 v[88:91], v5 offset:24576
    s_waitcnt lgkmcnt(4)
    v_mfma_f32_32x32x16_bf16 v[144:159], v[96:99], v[72:75], v[144:159]
    ds_read_b128 v[92:95], v6 offset:24576
    s_waitcnt lgkmcnt(4)
    v_mfma_f32_32x32x16_bf16 v[144:159], v[100:103], v[76:79], v[144:159]
    ds_read_b128 v[96:99], v7 offset:24576
    s_waitcnt lgkmcnt(4)
    v_mfma_f32_32x32x16_bf16 v[160:175], v[80:83], v[48:51], 0
    ds_read_b128 v[100:103], v8 offset:24576
    s_waitcnt lgkmcnt(4)
    v_mfma_f32_32x32x16_bf16 v[160:175], v[84:87], v[52:55], v[160:175]
    ds_read_b128 v[80:83], v9 offset:24576
    s_waitcnt lgkmcnt(4)
    v_mfma_f32_32x32x16_bf16 v[160:175], v[88:91], v[56:59], v[160:175]
    ds_read_b128 v[84:87], v10 offset:24576
    s_waitcnt lgkmcnt(4)
    v_mfma_f32_32x32x16_bf16 v[160:175], v[92:95], v[60:63], v[160:175]
    ds_read_b128 v[88:91], v3 offset:32768
    s_waitcnt lgkmcnt(4)
    v_mfma_f32_32x32x16_bf16 v[160:175], v[96:99], v[64:67], v[160:175]
    ds_read_b128 v[92:95], v4 offset:32768
    s_waitcnt lgkmcnt(4)
    v_mfma_f32_32x32x16_bf16 v[160:175], v[100:103], v[68:71], v[160:175]
    ds_read_b128 v[96:99], v5 offset:32768
    s_waitcnt lgkmcnt(4)
    v_mfma_f32_32x32x16_bf16 v[160:175], v[80:83], v[72:75], v[160:175]
    ds_read_b128 v[100:103], v6 offset:32768
    s_waitcnt lgkmcnt(4)
    v_mfma_f32_32x32x16_bf16 v[160:175], v[84:87], v[76:79], v[160:175]
    ds_read_b128 v[80:83], v7 offset:32768
    s_waitcnt lgkmcnt(4)
    v_mfma_f32_32x32x16_bf16 v[176:191], v[88:91], v[48:51], 0
    ds_read_b128 v[84:87], v8 offset:32768
    s_waitcnt lgkmcnt(4)
    v_mfma_f32_32x32x16_bf16 v[176:191], v[92:95], v[52:55], v[176:191]
    ds_read_b128 v[88:91], v9 offset:32768
    s_waitcnt lgkmcnt(4)
    v_mfma_f32_32x32x16_bf16 v[176:191], v[96:99], v[56:59], v[176:191]
    ds_read_b128 v[92:95], v10 offset:32768
    s_waitcnt lgkmcnt(4)
    v_mfma_f32_32x32x16_bf16 v[176:191], v[100:103], v[60:63], v[176:191]
    ds_read_b128 v[96:99], v3 offset:40960
    s_waitcnt lgkmcnt(4)
    v_mfma_f32_32x32x16_bf16 v[176:191], v[80:83], v[64:67], v[176:191]
    ds_read_b128 v[100:103], v4 offset:40960
    s_waitcnt lgkmcnt(4)
    v_mfma_f32_32x32x16_bf16 v[176:191], v[84:87], v[68:71], v[176:191]
    ds_read_b128 v[80:83], v5 offset:40960
    s_waitcnt lgkmcnt(4)
    v_mfma_f32_32x32x16_bf16 v[176:191], v[88:91], v[72:75], v[176:191]
    ds_read_b128 v[84:87], v6 offset:40960
    s_waitcnt lgkmcnt(4)
    v_mfma_f32_32x32x16_bf16 v[176:191], v[92:95], v[76:79], v[176:191]
    ds_read_b128 v[88:91], v7 offset:40960
    s_waitcnt lgkmcnt(4)
    v_mfma_f32_32x32x16_bf16 v[192:207], v[96:99], v[48:51], 0
    ds_read_b128 v[92:95], v8 offset:40960
    s_waitcnt lgkmcnt(4)
    v_mfma_f32_32x32x16_bf16 v[192:207], v[100:103], v[52:55], v[192:207]
    ds_read_b128 v[96:99], v9 offset:40960
    s_waitcnt lgkmcnt(4)
    v_mfma_f32_32x32x16_bf16 v[192:207], v[80:83], v[56:59], v[192:207]
    ds_read_b128 v[100:103], v10 offset:40960
    s_waitcnt lgkmcnt(4)
    v_mfma_f32_32x32x16_bf16 v[192:207], v[84:87], v[60:63], v[192:207]
    ds_read_b128 v[80:83], v3 offset:49152
    s_waitcnt lgkmcnt(4)
    v_mfma_f32_32x32x16_bf16 v[192:207], v[88:91], v[64:67], v[192:207]
    ds_read_b128 v[84:87], v4 offset:49152
    s_waitcnt lgkmcnt(4)
    v_mfma_f32_32x32x16_bf16 v[192:207], v[92:95], v[68:71], v[192:207]
    ds_read_b128 v[88:91], v5 offset:49152
    s_waitcnt lgkmcnt(4)
    v_mfma_f32_32x32x16_bf16 v[192:207], v[96:99], v[72:75], v[192:207]
    ds_read_b128 v[92:95], v6 offset:49152
    s_waitcnt lgkmcnt(4)
    v_mfma_f32_32x32x16_bf16 v[192:207], v[100:103], v[76:79], v[192:207]
    ds_read_b128 v[96:99], v7 offset:49152
    s_waitcnt lgkmcnt(4)
    v_mfma_f32_32x32x16_bf16 v[208:223], v[80:83], v[48:51], 0
    ds_read_b128 v[100:103], v8 offset:49152
    s_waitcnt lgkmcnt(4)
    v_mfma_f32_32x32x16_bf16 v[208:223], v[84:87], v[52:55], v[208:223]
    ds_read_b128 v[80:83], v9 offset:49152
    s_waitcnt lgkmcnt(4)
    v_mfma_f32_32x32x16_bf16 v[208:223], v[88:91], v[56:59], v[208:223]
    ds_read_b128 v[84:87], v10 offset:49152
    s_waitcnt lgkmcnt(4)
    v_mfma_f32_32x32x16_bf16 v[208:223], v[92:95], v[60:63], v[208:223]
    ds_read_b128 v[88:91], v3 offset:57344
    s_waitcnt lgkmcnt(4)
    v_mfma_f32_32x32x16_bf16 v[208:223], v[96:99], v[64:67], v[208:223]
    ds_read_b128 v[92:95], v4 offset:57344
    s_waitcnt lgkmcnt(4)
    v_mfma_f32_32x32x16_bf16 v[208:223], v[100:103], v[68:71], v[208:223]
    ds_read_b128 v[96:99], v5 offset:57344
    s_waitcnt lgkmcnt(4)
    v_mfma_f32_32x32x16_bf16 v[208:223], v[80:83], v[72:75], v[208:223]
    ds_read_b128 v[100:103], v6 offset:57344
    s_waitcnt lgkmcnt(4)
    v_mfma_f32_32x32x16_bf16 v[208:223], v[84:87], v[76:79], v[208:223]
    ds_read_b128 v[80:83], v7 offset:57344
    s_waitcnt lgkmcnt(4)
    v_mfma_f32_32x32x16_bf16 v[224:239], v[88:91], v[48:51], 0
    ds_read_b128 v[84:87], v8 offset:57344
    s_waitcnt lgkmcnt(4)
    v_mfma_f32_32x32x16_bf16 v[224:239], v[92:95], v[52:55], v[224:239]
    ds_read_b128 v[88:91], v9 offset:57344
    s_waitcnt lgkmcnt(4)
    v_mfma_f32_32x32x16_bf16 v[224:239], v[96:99], v[56:59], v[224:239]
    ds_read_b128 v[92:95], v10 offset:57344
    s_waitcnt lgkmcnt(4)
    v_mfma_f32_32x32x16_bf16 v[224:239], v[100:103], v[60:63], v[224:239]
    s_waitcnt lgkmcnt(3)
    v_mfma_f32_32x32x16_bf16 v[224:239], v[80:83], v[64:67], v[224:239]
    s_waitcnt lgkmcnt(2)
    v_mfma_f32_32x32x16_bf16 v[224:239], v[84:87], v[68:71], v[224:239]
    s_waitcnt lgkmcnt(1)
    v_mfma_f32_32x32x16_bf16 v[224:239], v[88:91], v[72:75], v[224:239]
    s_waitcnt lgkmcnt(0)
    v_mfma_f32_32x32x16_bf16 v[224:239], v[92:95], v[76:79], v[224:239]
    s_add_u32 s34, s30, 24576
    buffer_load_dwordx4 v[48:51], v1, s[12:15], s34 offen offset:0
    buffer_load_dwordx4 v[52:55], v1, s[12:15], s34 offen offset:32
    buffer_load_dwordx4 v[56:59], v1, s[12:15], s34 offen offset:64
    buffer_load_dwordx4 v[60:63], v1, s[12:15], s34 offen offset:96
    buffer_load_dwordx4 v[64:67], v1, s[12:15], s34 offen offset:128
    buffer_load_dwordx4 v[68:71], v1, s[12:15], s34 offen offset:160
    buffer_load_dwordx4 v[72:75], v1, s[12:15], s34 offen offset:192
    buffer_load_dwordx4 v[76:79], v1, s[12:15], s34 offen offset:224
    s_nop 7
    v_max3_f32 v104, v112, v113, v114
    v_max3_f32 v106, v115, v116, v117
    v_max3_f32 v104, v104, v118, v119
    v_max3_f32 v106, v106, v120, v121
    v_max3_f32 v104, v104, v122, v123
    v_max3_f32 v106, v106, v124, v125
    v_max3_f32 v104, v104, v126, v127
    v_max3_f32 v106, v106, v128, v129
    v_max3_f32 v104, v104, v130, v131
    v_max3_f32 v106, v106, v132, v133
    v_max3_f32 v104, v104, v134, v135
    v_max3_f32 v106, v106, v136, v137
    v_max3_f32 v104, v104, v138, v139
    v_max3_f32 v106, v106, v140, v141
    v_max3_f32 v104, v104, v142, v143
    v_max3_f32 v106, v106, v144, v145
    v_max3_f32 v104, v104, v146, v147
    v_max3_f32 v106, v106, v148, v149
    v_max3_f32 v104, v104, v150, v151
    v_max3_f32 v106, v106, v152, v153
    v_max3_f32 v104, v104, v154, v155
    v_max3_f32 v106, v106, v156, v157
    v_max3_f32 v104, v104, v158, v159
    v_max3_f32 v106, v106, v160, v161
    v_max3_f32 v104, v104, v162, v163
    v_max3_f32 v106, v106, v164, v165
    v_max3_f32 v104, v104, v166, v167
    v_max3_f32 v106, v106, v168, v169
    v_max3_f32 v104, v104, v170, v171
    v_max3_f32 v106, v106, v172, v173
    v_max3_f32 v104, v104, v174, v175
    v_max3_f32 v106, v106, v176, v177
    v_max3_f32 v104, v104, v178, v179
    v_max3_f32 v106, v106, v180, v181
    v_max3_f32 v104, v104, v182, v183
    v_max3_f32 v106, v106, v184, v185
    v_max3_f32 v104, v104, v186, v187
    v_max3_f32 v106, v106, v188, v189
    v_max3_f32 v104, v104, v190, v191
    v_max3_f32 v106, v106, v192, v193
    v_max3_f32 v104, v104, v194, v195
    v_max3_f32 v106, v106, v196, v197
    v_max3_f32 v104, v104, v198, v199
    v_max3_f32 v106, v106, v200, v201
    v_max3_f32 v104, v104, v202, v203
    v_max3_f32 v106, v106, v204, v205
    v_max3_f32 v104, v104, v206, v207
    v_max3_f32 v106, v106, v208, v209
    v_max3_f32 v104, v104, v210, v211
    v_max3_f32 v106, v106, v212, v213
    v_max3_f32 v104, v104, v214, v215
    v_max3_f32 v106, v106, v216, v217
    v_max3_f32 v104, v104, v218, v219
    v_max3_f32 v106, v106, v220, v221
    v_max3_f32 v104, v104, v222, v223
    v_max3_f32 v106, v106, v224, v225
    v_max3_f32 v104, v104, v226, v227
    v_max3_f32 v106, v106, v228, v229
    v_max3_f32 v104, v104, v230, v231
    v_max3_f32 v106, v106, v232, v233
    v_max3_f32 v104, v104, v234, v235
    v_max3_f32 v106, v106, v236, v237
    v_max3_f32 v104, v104, v238, v239
    v_max_f32 v104, v104, v106
    v_mov_b32 v106, v104
    s_nop 1
    v_permlane32_swap_b32 v104, v106
    v_max_f32 v104, v104, v106
    v_mul_f32 v105, s32, v104
    v_mov_b32 v107, 0
    v_mov_b32 v108, 0
    v_mov_b32 v109, 0
    v_mov_b32 v110, 0
    v_fma_f32 v112, v112, s32, -v105
    v_fma_f32 v113, v113, s32, -v105
    v_fma_f32 v114, v114, s32, -v105
    v_fma_f32 v115, v115, s32, -v105
    v_exp_f32 v112, v112
    v_exp_f32 v113, v113
    v_exp_f32 v114, v114
    v_exp_f32 v115, v115
    s_nop 0
    v_add_f32 v107, v107, v112
    v_add_f32 v108, v108, v113
    v_add_f32 v109, v109, v114
    v_add_f32 v110, v110, v115
    v_cvt_pk_bf16_f32 v112, v112, v113
    v_cvt_pk_bf16_f32 v113, v114, v115
    v_fma_f32 v116, v116, s32, -v105
    v_fma_f32 v117, v117, s32, -v105
    v_fma_f32 v118, v118, s32, -v105
    v_fma_f32 v119, v119, s32, -v105
    v_exp_f32 v116, v116
    v_exp_f32 v117, v117
    v_exp_f32 v118, v118
    v_exp_f32 v119, v119
    s_nop 0
    v_add_f32 v107, v107, v116
    v_add_f32 v108, v108, v117
    v_add_f32 v109, v109, v118
    v_add_f32 v110, v110, v119
    v_cvt_pk_bf16_f32 v114, v116, v117
    v_cvt_pk_bf16_f32 v115, v118, v119
    v_fma_f32 v120, v120, s32, -v105
    v_fma_f32 v121, v121, s32, -v105
    v_fma_f32 v122, v122, s32, -v105
    v_fma_f32 v123, v123, s32, -v105
    v_exp_f32 v120, v120
    v_exp_f32 v121, v121
    v_exp_f32 v122, v122
    v_exp_f32 v123, v123
    s_nop 0
    v_add_f32 v107, v107, v120
    v_add_f32 v108, v108, v121
    v_add_f32 v109, v109, v122
    v_add_f32 v110, v110, v123
    v_cvt_pk_bf16_f32 v116, v120, v121
    v_cvt_pk_bf16_f32 v117, v122, v123
    v_fma_f32 v124, v124, s32, -v105
    v_fma_f32 v125, v125, s32, -v105
    v_fma_f32 v126, v126, s32, -v105
    v_fma_f32 v127, v127, s32, -v105
    v_exp_f32 v124, v124
    v_exp_f32 v125, v125
    v_exp_f32 v126, v126
    v_exp_f32 v127, v127
    s_nop 0
    v_add_f32 v107, v107, v124
    v_add_f32 v108, v108, v125
    v_add_f32 v109, v109, v126
    v_add_f32 v110, v110, v127
    v_cvt_pk_bf16_f32 v118, v124, v125
    v_cvt_pk_bf16_f32 v119, v126, v127
    v_fma_f32 v128, v128, s32, -v105
    v_fma_f32 v129, v129, s32, -v105
    v_fma_f32 v130, v130, s32, -v105
    v_fma_f32 v131, v131, s32, -v105
    v_exp_f32 v128, v128
    v_exp_f32 v129, v129
    v_exp_f32 v130, v130
    v_exp_f32 v131, v131
    s_nop 0
    v_add_f32 v107, v107, v128
    v_add_f32 v108, v108, v129
    v_add_f32 v109, v109, v130
    v_add_f32 v110, v110, v131
    v_cvt_pk_bf16_f32 v120, v128, v129
    v_cvt_pk_bf16_f32 v121, v130, v131
    v_fma_f32 v132, v132, s32, -v105
    v_fma_f32 v133, v133, s32, -v105
    v_fma_f32 v134, v134, s32, -v105
    v_fma_f32 v135, v135, s32, -v105
    v_exp_f32 v132, v132
    v_exp_f32 v133, v133
    v_exp_f32 v134, v134
    v_exp_f32 v135, v135
    s_nop 0
    v_add_f32 v107, v107, v132
    v_add_f32 v108, v108, v133
    v_add_f32 v109, v109, v134
    v_add_f32 v110, v110, v135
    v_cvt_pk_bf16_f32 v122, v132, v133
    v_cvt_pk_bf16_f32 v123, v134, v135
    v_fma_f32 v136, v136, s32, -v105
    v_fma_f32 v137, v137, s32, -v105
    v_fma_f32 v138, v138, s32, -v105
    v_fma_f32 v139, v139, s32, -v105
    v_exp_f32 v136, v136
    v_exp_f32 v137, v137
    v_exp_f32 v138, v138
    v_exp_f32 v139, v139
    s_nop 0
    v_add_f32 v107, v107, v136
    v_add_f32 v108, v108, v137
    v_add_f32 v109, v109, v138
    v_add_f32 v110, v110, v139
    v_cvt_pk_bf16_f32 v124, v136, v137
    v_cvt_pk_bf16_f32 v125, v138, v139
    v_fma_f32 v140, v140, s32, -v105
    v_fma_f32 v141, v141, s32, -v105
    v_fma_f32 v142, v142, s32, -v105
    v_fma_f32 v143, v143, s32, -v105
    v_exp_f32 v140, v140
    v_exp_f32 v141, v141
    v_exp_f32 v142, v142
    v_exp_f32 v143, v143
    s_nop 0
    v_add_f32 v107, v107, v140
    v_add_f32 v108, v108, v141
    v_add_f32 v109, v109, v142
    v_add_f32 v110, v110, v143
    v_cvt_pk_bf16_f32 v126, v140, v141
    v_cvt_pk_bf16_f32 v127, v142, v143
    v_fma_f32 v144, v144, s32, -v105
    v_fma_f32 v145, v145, s32, -v105
    v_fma_f32 v146, v146, s32, -v105
    v_fma_f32 v147, v147, s32, -v105
    v_exp_f32 v144, v144
    v_exp_f32 v145, v145
    v_exp_f32 v146, v146
    v_exp_f32 v147, v147
    s_nop 0
    v_add_f32 v107, v107, v144
    v_add_f32 v108, v108, v145
    v_add_f32 v109, v109, v146
    v_add_f32 v110, v110, v147
    v_cvt_pk_bf16_f32 v128, v144, v145
    v_cvt_pk_bf16_f32 v129, v146, v147
    v_fma_f32 v148, v148, s32, -v105
    v_fma_f32 v149, v149, s32, -v105
    v_fma_f32 v150, v150, s32, -v105
    v_fma_f32 v151, v151, s32, -v105
    v_exp_f32 v148, v148
    v_exp_f32 v149, v149
    v_exp_f32 v150, v150
    v_exp_f32 v151, v151
    s_nop 0
    v_add_f32 v107, v107, v148
    v_add_f32 v108, v108, v149
    v_add_f32 v109, v109, v150
    v_add_f32 v110, v110, v151
    v_cvt_pk_bf16_f32 v130, v148, v149
    v_cvt_pk_bf16_f32 v131, v150, v151
    v_fma_f32 v152, v152, s32, -v105
    v_fma_f32 v153, v153, s32, -v105
    v_fma_f32 v154, v154, s32, -v105
    v_fma_f32 v155, v155, s32, -v105
    v_exp_f32 v152, v152
    v_exp_f32 v153, v153
    v_exp_f32 v154, v154
    v_exp_f32 v155, v155
    s_nop 0
    v_add_f32 v107, v107, v152
    v_add_f32 v108, v108, v153
    v_add_f32 v109, v109, v154
    v_add_f32 v110, v110, v155
    v_cvt_pk_bf16_f32 v132, v152, v153
    v_cvt_pk_bf16_f32 v133, v154, v155
    v_fma_f32 v156, v156, s32, -v105
    v_fma_f32 v157, v157, s32, -v105
    v_fma_f32 v158, v158, s32, -v105
    v_fma_f32 v159, v159, s32, -v105
    v_exp_f32 v156, v156
    v_exp_f32 v157, v157
    v_exp_f32 v158, v158
    v_exp_f32 v159, v159
    s_nop 0
    v_add_f32 v107, v107, v156
    v_add_f32 v108, v108, v157
    v_add_f32 v109, v109, v158
    v_add_f32 v110, v110, v159
    v_cvt_pk_bf16_f32 v134, v156, v157
    v_cvt_pk_bf16_f32 v135, v158, v159
    v_fma_f32 v160, v160, s32, -v105
    v_fma_f32 v161, v161, s32, -v105
    v_fma_f32 v162, v162, s32, -v105
    v_fma_f32 v163, v163, s32, -v105
    v_exp_f32 v160, v160
    v_exp_f32 v161, v161
    v_exp_f32 v162, v162
    v_exp_f32 v163, v163
    s_nop 0
    v_add_f32 v107, v107, v160
    v_add_f32 v108, v108, v161
    v_add_f32 v109, v109, v162
    v_add_f32 v110, v110, v163
    v_cvt_pk_bf16_f32 v136, v160, v161
    v_cvt_pk_bf16_f32 v137, v162, v163
    v_fma_f32 v164, v164, s32, -v105
    v_fma_f32 v165, v165, s32, -v105
    v_fma_f32 v166, v166, s32, -v105
    v_fma_f32 v167, v167, s32, -v105
    v_exp_f32 v164, v164
    v_exp_f32 v165, v165
    v_exp_f32 v166, v166
    v_exp_f32 v167, v167
    s_nop 0
    v_add_f32 v107, v107, v164
    v_add_f32 v108, v108, v165
    v_add_f32 v109, v109, v166
    v_add_f32 v110, v110, v167
    v_cvt_pk_bf16_f32 v138, v164, v165
    v_cvt_pk_bf16_f32 v139, v166, v167
    v_fma_f32 v168, v168, s32, -v105
    v_fma_f32 v169, v169, s32, -v105
    v_fma_f32 v170, v170, s32, -v105
    v_fma_f32 v171, v171, s32, -v105
    v_exp_f32 v168, v168
    v_exp_f32 v169, v169
    v_exp_f32 v170, v170
    v_exp_f32 v171, v171
    s_nop 0
    v_add_f32 v107, v107, v168
    v_add_f32 v108, v108, v169
    v_add_f32 v109, v109, v170
    v_add_f32 v110, v110, v171
    v_cvt_pk_bf16_f32 v140, v168, v169
    v_cvt_pk_bf16_f32 v141, v170, v171
    v_fma_f32 v172, v172, s32, -v105
    v_fma_f32 v173, v173, s32, -v105
    v_fma_f32 v174, v174, s32, -v105
    v_fma_f32 v175, v175, s32, -v105
    v_exp_f32 v172, v172
    v_exp_f32 v173, v173
    v_exp_f32 v174, v174
    v_exp_f32 v175, v175
    s_nop 0
    v_add_f32 v107, v107, v172
    v_add_f32 v108, v108, v173
    v_add_f32 v109, v109, v174
    v_add_f32 v110, v110, v175
    v_cvt_pk_bf16_f32 v142, v172, v173
    v_cvt_pk_bf16_f32 v143, v174, v175
    v_fma_f32 v176, v176, s32, -v105
    v_fma_f32 v177, v177, s32, -v105
    v_fma_f32 v178, v178, s32, -v105
    v_fma_f32 v179, v179, s32, -v105
    v_exp_f32 v176, v176
    v_exp_f32 v177, v177
    v_exp_f32 v178, v178
    v_exp_f32 v179, v179
    s_nop 0
    v_add_f32 v107, v107, v176
    v_add_f32 v108, v108, v177
    v_add_f32 v109, v109, v178
    v_add_f32 v110, v110, v179
    v_cvt_pk_bf16_f32 v144, v176, v177
    v_cvt_pk_bf16_f32 v145, v178, v179
    v_fma_f32 v180, v180, s32, -v105
    v_fma_f32 v181, v181, s32, -v105
    v_fma_f32 v182, v182, s32, -v105
    v_fma_f32 v183, v183, s32, -v105
    v_exp_f32 v180, v180
    v_exp_f32 v181, v181
    v_exp_f32 v182, v182
    v_exp_f32 v183, v183
    s_nop 0
    v_add_f32 v107, v107, v180
    v_add_f32 v108, v108, v181
    v_add_f32 v109, v109, v182
    v_add_f32 v110, v110, v183
    v_cvt_pk_bf16_f32 v146, v180, v181
    v_cvt_pk_bf16_f32 v147, v182, v183
    v_fma_f32 v184, v184, s32, -v105
    v_fma_f32 v185, v185, s32, -v105
    v_fma_f32 v186, v186, s32, -v105
    v_fma_f32 v187, v187, s32, -v105
    v_exp_f32 v184, v184
    v_exp_f32 v185, v185
    v_exp_f32 v186, v186
    v_exp_f32 v187, v187
    s_nop 0
    v_add_f32 v107, v107, v184
    v_add_f32 v108, v108, v185
    v_add_f32 v109, v109, v186
    v_add_f32 v110, v110, v187
    v_cvt_pk_bf16_f32 v148, v184, v185
    v_cvt_pk_bf16_f32 v149, v186, v187
    v_fma_f32 v188, v188, s32, -v105
    v_fma_f32 v189, v189, s32, -v105
    v_fma_f32 v190, v190, s32, -v105
    v_fma_f32 v191, v191, s32, -v105
    v_exp_f32 v188, v188
    v_exp_f32 v189, v189
    v_exp_f32 v190, v190
    v_exp_f32 v191, v191
    s_nop 0
    v_add_f32 v107, v107, v188
    v_add_f32 v108, v108, v189
    v_add_f32 v109, v109, v190
    v_add_f32 v110, v110, v191
    v_cvt_pk_bf16_f32 v150, v188, v189
    v_cvt_pk_bf16_f32 v151, v190, v191
    v_fma_f32 v192, v192, s32, -v105
    v_fma_f32 v193, v193, s32, -v105
    v_fma_f32 v194, v194, s32, -v105
    v_fma_f32 v195, v195, s32, -v105
    v_exp_f32 v192, v192
    v_exp_f32 v193, v193
    v_exp_f32 v194, v194
    v_exp_f32 v195, v195
    s_nop 0
    v_add_f32 v107, v107, v192
    v_add_f32 v108, v108, v193
    v_add_f32 v109, v109, v194
    v_add_f32 v110, v110, v195
    v_cvt_pk_bf16_f32 v152, v192, v193
    v_cvt_pk_bf16_f32 v153, v194, v195
    v_fma_f32 v196, v196, s32, -v105
    v_fma_f32 v197, v197, s32, -v105
    v_fma_f32 v198, v198, s32, -v105
    v_fma_f32 v199, v199, s32, -v105
    v_exp_f32 v196, v196
    v_exp_f32 v197, v197
    v_exp_f32 v198, v198
    v_exp_f32 v199, v199
    s_nop 0
    v_add_f32 v107, v107, v196
    v_add_f32 v108, v108, v197
    v_add_f32 v109, v109, v198
    v_add_f32 v110, v110, v199
    v_cvt_pk_bf16_f32 v154, v196, v197
    v_cvt_pk_bf16_f32 v155, v198, v199
    v_fma_f32 v200, v200, s32, -v105
    v_fma_f32 v201, v201, s32, -v105
    v_fma_f32 v202, v202, s32, -v105
    v_fma_f32 v203, v203, s32, -v105
    v_exp_f32 v200, v200
    v_exp_f32 v201, v201
    v_exp_f32 v202, v202
    v_exp_f32 v203, v203
    s_nop 0
    v_add_f32 v107, v107, v200
    v_add_f32 v108, v108, v201
    v_add_f32 v109, v109, v202
    v_add_f32 v110, v110, v203
    v_cvt_pk_bf16_f32 v156, v200, v201
    v_cvt_pk_bf16_f32 v157, v202, v203
    v_fma_f32 v204, v204, s32, -v105
    v_fma_f32 v205, v205, s32, -v105
    v_fma_f32 v206, v206, s32, -v105
    v_fma_f32 v207, v207, s32, -v105
    v_exp_f32 v204, v204
    v_exp_f32 v205, v205
    v_exp_f32 v206, v206
    v_exp_f32 v207, v207
    s_nop 0
    v_add_f32 v107, v107, v204
    v_add_f32 v108, v108, v205
    v_add_f32 v109, v109, v206
    v_add_f32 v110, v110, v207
    v_cvt_pk_bf16_f32 v158, v204, v205
    v_cvt_pk_bf16_f32 v159, v206, v207
    v_fma_f32 v208, v208, s32, -v105
    v_fma_f32 v209, v209, s32, -v105
    v_fma_f32 v210, v210, s32, -v105
    v_fma_f32 v211, v211, s32, -v105
    v_exp_f32 v208, v208
    v_exp_f32 v209, v209
    v_exp_f32 v210, v210
    v_exp_f32 v211, v211
    s_nop 0
    v_add_f32 v107, v107, v208
    v_add_f32 v108, v108, v209
    v_add_f32 v109, v109, v210
    v_add_f32 v110, v110, v211
    v_cvt_pk_bf16_f32 v160, v208, v209
    v_cvt_pk_bf16_f32 v161, v210, v211
    v_fma_f32 v212, v212, s32, -v105
    v_fma_f32 v213, v213, s32, -v105
    v_fma_f32 v214, v214, s32, -v105
    v_fma_f32 v215, v215, s32, -v105
    v_exp_f32 v212, v212
    v_exp_f32 v213, v213
    v_exp_f32 v214, v214
    v_exp_f32 v215, v215
    s_nop 0
    v_add_f32 v107, v107, v212
    v_add_f32 v108, v108, v213
    v_add_f32 v109, v109, v214
    v_add_f32 v110, v110, v215
    v_cvt_pk_bf16_f32 v162, v212, v213
    v_cvt_pk_bf16_f32 v163, v214, v215
    v_fma_f32 v216, v216, s32, -v105
    v_fma_f32 v217, v217, s32, -v105
    v_fma_f32 v218, v218, s32, -v105
    v_fma_f32 v219, v219, s32, -v105
    v_exp_f32 v216, v216
    v_exp_f32 v217, v217
    v_exp_f32 v218, v218
    v_exp_f32 v219, v219
    s_nop 0
    v_add_f32 v107, v107, v216
    v_add_f32 v108, v108, v217
    v_add_f32 v109, v109, v218
    v_add_f32 v110, v110, v219
    v_cvt_pk_bf16_f32 v164, v216, v217
    v_cvt_pk_bf16_f32 v165, v218, v219
    v_fma_f32 v220, v220, s32, -v105
    v_fma_f32 v221, v221, s32, -v105
    v_fma_f32 v222, v222, s32, -v105
    v_fma_f32 v223, v223, s32, -v105
    v_exp_f32 v220, v220
    v_exp_f32 v221, v221
    v_exp_f32 v222, v222
    v_exp_f32 v223, v223
    s_nop 0
    v_add_f32 v107, v107, v220
    v_add_f32 v108, v108, v221
    v_add_f32 v109, v109, v222
    v_add_f32 v110, v110, v223
    v_cvt_pk_bf16_f32 v166, v220, v221
    v_cvt_pk_bf16_f32 v167, v222, v223
    v_fma_f32 v224, v224, s32, -v105
    v_fma_f32 v225, v225, s32, -v105
    v_fma_f32 v226, v226, s32, -v105
    v_fma_f32 v227, v227, s32, -v105
    v_exp_f32 v224, v224
    v_exp_f32 v225, v225
    v_exp_f32 v226, v226
    v_exp_f32 v227, v227
    s_nop 0
    v_add_f32 v107, v107, v224
    v_add_f32 v108, v108, v225
    v_add_f32 v109, v109, v226
    v_add_f32 v110, v110, v227
    v_cvt_pk_bf16_f32 v168, v224, v225
    v_cvt_pk_bf16_f32 v169, v226, v227
    v_fma_f32 v228, v228, s32, -v105
    v_fma_f32 v229, v229, s32, -v105
    v_fma_f32 v230, v230, s32, -v105
    v_fma_f32 v231, v231, s32, -v105
    v_exp_f32 v228, v228
    v_exp_f32 v229, v229
    v_exp_f32 v230, v230
    v_exp_f32 v231, v231
    s_nop 0
    v_add_f32 v107, v107, v228
    v_add_f32 v108, v108, v229
    v_add_f32 v109, v109, v230
    v_add_f32 v110, v110, v231
    v_cvt_pk_bf16_f32 v170, v228, v229
    v_cvt_pk_bf16_f32 v171, v230, v231
    v_fma_f32 v232, v232, s32, -v105
    v_fma_f32 v233, v233, s32, -v105
    v_fma_f32 v234, v234, s32, -v105
    v_fma_f32 v235, v235, s32, -v105
    v_exp_f32 v232, v232
    v_exp_f32 v233, v233
    v_exp_f32 v234, v234
    v_exp_f32 v235, v235
    s_nop 0
    v_add_f32 v107, v107, v232
    v_add_f32 v108, v108, v233
    v_add_f32 v109, v109, v234
    v_add_f32 v110, v110, v235
    v_cvt_pk_bf16_f32 v172, v232, v233
    v_cvt_pk_bf16_f32 v173, v234, v235
    v_fma_f32 v236, v236, s32, -v105
    v_fma_f32 v237, v237, s32, -v105
    v_fma_f32 v238, v238, s32, -v105
    v_fma_f32 v239, v239, s32, -v105
    v_exp_f32 v236, v236
    v_exp_f32 v237, v237
    v_exp_f32 v238, v238
    v_exp_f32 v239, v239
    s_nop 0
    v_add_f32 v107, v107, v236
    v_add_f32 v108, v108, v237
    v_add_f32 v109, v109, v238
    v_add_f32 v110, v110, v239
    v_cvt_pk_bf16_f32 v174, v236, v237
    v_cvt_pk_bf16_f32 v175, v238, v239
    v_add_f32 v107, v107, v108
    v_add_f32 v109, v109, v110
    v_add_f32 v107, v107, v109
    v_mov_b32 v106, v107
    s_nop 1
    v_permlane32_swap_b32 v107, v106
    v_add_f32 v107, v107, v106
    v_rcp_f32 v111, v107
    ds_read_b64_tr_b16 v[80:81], v11 offset:0
    ds_read_b64_tr_b16 v[82:83], v11 offset:2048
    ds_read_b64_tr_b16 v[84:85], v12 offset:0
    ds_read_b64_tr_b16 v[86:87], v12 offset:2048
    ds_read_b64_tr_b16 v[88:89], v13 offset:0
    ds_read_b64_tr_b16 v[90:91], v13 offset:2048
    ds_read_b64_tr_b16 v[92:93], v14 offset:0
    ds_read_b64_tr_b16 v[94:95], v14 offset:2048
    ds_read_b64_tr_b16 v[96:97], v11 offset:4096
    ds_read_b64_tr_b16 v[98:99], v11 offset:6144
    s_waitcnt lgkmcnt(8)
    v_mfma_f32_32x32x16_bf16 v[176:191], v[80:83], v[112:115], 0
    ds_read_b64_tr_b16 v[100:101], v12 offset:4096
    ds_read_b64_tr_b16 v[102:103], v12 offset:6144
    s_waitcnt lgkmcnt(8)
    v_mfma_f32_32x32x16_bf16 v[192:207], v[84:87], v[112:115], 0
    ds_read_b64_tr_b16 v[80:81], v13 offset:4096
    ds_read_b64_tr_b16 v[82:83], v13 offset:6144
    s_waitcnt lgkmcnt(8)
    v_mfma_f32_32x32x16_bf16 v[208:223], v[88:91], v[112:115], 0
    ds_read_b64_tr_b16 v[84:85], v14 offset:4096
    ds_read_b64_tr_b16 v[86:87], v14 offset:6144
    s_waitcnt lgkmcnt(8)
    v_mfma_f32_32x32x16_bf16 v[224:239], v[92:95], v[112:115], 0
    ds_read_b64_tr_b16 v[88:89], v11 offset:8192
    ds_read_b64_tr_b16 v[90:91], v11 offset:10240
    s_waitcnt lgkmcnt(8)
    v_mfma_f32_32x32x16_bf16 v[176:191], v[96:99], v[116:119], v[176:191]
    ds_read_b64_tr_b16 v[92:93], v12 offset:8192
    ds_read_b64_tr_b16 v[94:95], v12 offset:10240
    s_waitcnt lgkmcnt(8)
    v_mfma_f32_32x32x16_bf16 v[192:207], v[100:103], v[116:119], v[192:207]
    ds_read_b64_tr_b16 v[96:97], v13 offset:8192
    ds_read_b64_tr_b16 v[98:99], v13 offset:10240
    s_waitcnt lgkmcnt(8)
    v_mfma_f32_32x32x16_bf16 v[208:223], v[80:83], v[116:119], v[208:223]
    ds_read_b64_tr_b16 v[100:101], v14 offset:8192
    ds_read_b64_tr_b16 v[102:103], v14 offset:10240
    s_waitcnt lgkmcnt(8)
    v_mfma_f32_32x32x16_bf16 v[224:239], v[84:87], v[116:119], v[224:239]
    ds_read_b64_tr_b16 v[80:81], v11 offset:12288
    ds_read_b64_tr_b16 v[82:83], v11 offset:14336
    s_waitcnt lgkmcnt(8)
    v_mfma_f32_32x32x16_bf16 v[176:191], v[88:91], v[120:123], v[176:191]
    ds_read_b64_tr_b16 v[84:85], v12 offset:12288
    ds_read_b64_tr_b16 v[86:87], v12 offset:14336
    s_waitcnt lgkmcnt(8)
    v_mfma_f32_32x32x16_bf16 v[192:207], v[92:95], v[120:123], v[192:207]
    ds_read_b64_tr_b16 v[88:89], v13 offset:12288
    ds_read_b64_tr_b16 v[90:91], v13 offset:14336
    s_waitcnt lgkmcnt(8)
    v_mfma_f32_32x32x16_bf16 v[208:223], v[96:99], v[120:123], v[208:223]
    ds_read_b64_tr_b16 v[92:93], v14 offset:12288
    ds_read_b64_tr_b16 v[94:95], v14 offset:14336
    s_waitcnt lgkmcnt(8)
    v_mfma_f32_32x32x16_bf16 v[224:239], v[100:103], v[120:123], v[224:239]
    ds_read_b64_tr_b16 v[96:97], v11 offset:16384
    ds_read_b64_tr_b16 v[98:99], v11 offset:18432
    s_waitcnt lgkmcnt(8)
    v_mfma_f32_32x32x16_bf16 v[176:191], v[80:83], v[124:127], v[176:191]
    ds_read_b64_tr_b16 v[100:101], v12 offset:16384
    ds_read_b64_tr_b16 v[102:103], v12 offset:18432
    s_waitcnt lgkmcnt(8)
    v_mfma_f32_32x32x16_bf16 v[192:207], v[84:87], v[124:127], v[192:207]
    ds_read_b64_tr_b16 v[80:81], v13 offset:16384
    ds_read_b64_tr_b16 v[82:83], v13 offset:18432
    s_waitcnt lgkmcnt(8)
    v_mfma_f32_32x32x16_bf16 v[208:223], v[88:91], v[124:127], v[208:223]
    ds_read_b64_tr_b16 v[84:85], v14 offset:16384
    ds_read_b64_tr_b16 v[86:87], v14 offset:18432
    s_waitcnt lgkmcnt(8)
    v_mfma_f32_32x32x16_bf16 v[224:239], v[92:95], v[124:127], v[224:239]
    ds_read_b64_tr_b16 v[88:89], v11 offset:20480
    ds_read_b64_tr_b16 v[90:91], v11 offset:22528
    s_waitcnt lgkmcnt(8)
    v_mfma_f32_32x32x16_bf16 v[176:191], v[96:99], v[128:131], v[176:191]
    ds_read_b64_tr_b16 v[92:93], v12 offset:20480
    ds_read_b64_tr_b16 v[94:95], v12 offset:22528
    s_waitcnt lgkmcnt(8)
    v_mfma_f32_32x32x16_bf16 v[192:207], v[100:103], v[128:131], v[192:207]
    ds_read_b64_tr_b16 v[96:97], v13 offset:20480
    ds_read_b64_tr_b16 v[98:99], v13 offset:22528
    s_waitcnt lgkmcnt(8)
    v_mfma_f32_32x32x16_bf16 v[208:223], v[80:83], v[128:131], v[208:223]
    ds_read_b64_tr_b16 v[100:101], v14 offset:20480
    ds_read_b64_tr_b16 v[102:103], v14 offset:22528
    s_waitcnt lgkmcnt(8)
    v_mfma_f32_32x32x16_bf16 v[224:239], v[84:87], v[128:131], v[224:239]
    ds_read_b64_tr_b16 v[80:81], v11 offset:24576
    ds_read_b64_tr_b16 v[82:83], v11 offset:26624
    s_waitcnt lgkmcnt(8)
    v_mfma_f32_32x32x16_bf16 v[176:191], v[88:91], v[132:135], v[176:191]
    ds_read_b64_tr_b16 v[84:85], v12 offset:24576
    ds_read_b64_tr_b16 v[86:87], v12 offset:26624
    s_waitcnt lgkmcnt(8)
    v_mfma_f32_32x32x16_bf16 v[192:207], v[92:95], v[132:135], v[192:207]
    ds_read_b64_tr_b16 v[88:89], v13 offset:24576
    ds_read_b64_tr_b16 v[90:91], v13 offset:26624
    s_waitcnt lgkmcnt(8)
    v_mfma_f32_32x32x16_bf16 v[208:223], v[96:99], v[132:135], v[208:223]
    ds_read_b64_tr_b16 v[92:93], v14 offset:24576
    ds_read_b64_tr_b16 v[94:95], v14 offset:26624
    s_waitcnt lgkmcnt(8)
    v_mfma_f32_32x32x16_bf16 v[224:239], v[100:103], v[132:135], v[224:239]
    ds_read_b64_tr_b16 v[96:97], v11 offset:28672
    ds_read_b64_tr_b16 v[98:99], v11 offset:30720
    s_waitcnt lgkmcnt(8)
    v_mfma_f32_32x32x16_bf16 v[176:191], v[80:83], v[136:139], v[176:191]
    ds_read_b64_tr_b16 v[100:101], v12 offset:28672
    ds_read_b64_tr_b16 v[102:103], v12 offset:30720
    s_waitcnt lgkmcnt(8)
    v_mfma_f32_32x32x16_bf16 v[192:207], v[84:87], v[136:139], v[192:207]
    ds_read_b64_tr_b16 v[80:81], v13 offset:28672
    ds_read_b64_tr_b16 v[82:83], v13 offset:30720
    s_waitcnt lgkmcnt(8)
    v_mfma_f32_32x32x16_bf16 v[208:223], v[88:91], v[136:139], v[208:223]
    ds_read_b64_tr_b16 v[84:85], v14 offset:28672
    ds_read_b64_tr_b16 v[86:87], v14 offset:30720
    s_waitcnt lgkmcnt(8)
    v_mfma_f32_32x32x16_bf16 v[224:239], v[92:95], v[136:139], v[224:239]
    ds_read_b64_tr_b16 v[88:89], v11 offset:32768
    ds_read_b64_tr_b16 v[90:91], v11 offset:34816
    s_waitcnt lgkmcnt(8)
    v_mfma_f32_32x32x16_bf16 v[176:191], v[96:99], v[140:143], v[176:191]
    ds_read_b64_tr_b16 v[92:93], v12 offset:32768
    ds_read_b64_tr_b16 v[94:95], v12 offset:34816
    s_waitcnt lgkmcnt(8)
    v_mfma_f32_32x32x16_bf16 v[192:207], v[100:103], v[140:143], v[192:207]
    ds_read_b64_tr_b16 v[96:97], v13 offset:32768
    ds_read_b64_tr_b16 v[98:99], v13 offset:34816
    s_waitcnt lgkmcnt(8)
    v_mfma_f32_32x32x16_bf16 v[208:223], v[80:83], v[140:143], v[208:223]
    ds_read_b64_tr_b16 v[100:101], v14 offset:32768
    ds_read_b64_tr_b16 v[102:103], v14 offset:34816
    s_waitcnt lgkmcnt(8)
    v_mfma_f32_32x32x16_bf16 v[224:239], v[84:87], v[140:143], v[224:239]
    ds_read_b64_tr_b16 v[80:81], v11 offset:36864
    ds_read_b64_tr_b16 v[82:83], v11 offset:38912
    s_waitcnt lgkmcnt(8)
    v_mfma_f32_32x32x16_bf16 v[176:191], v[88:91], v[144:147], v[176:191]
    ds_read_b64_tr_b16 v[84:85], v12 offset:36864
    ds_read_b64_tr_b16 v[86:87], v12 offset:38912
    s_waitcnt lgkmcnt(8)
    v_mfma_f32_32x32x16_bf16 v[192:207], v[92:95], v[144:147], v[192:207]
    ds_read_b64_tr_b16 v[88:89], v13 offset:36864
    ds_read_b64_tr_b16 v[90:91], v13 offset:38912
    s_waitcnt lgkmcnt(8)
    v_mfma_f32_32x32x16_bf16 v[208:223], v[96:99], v[144:147], v[208:223]
    ds_read_b64_tr_b16 v[92:93], v14 offset:36864
    ds_read_b64_tr_b16 v[94:95], v14 offset:38912
    s_waitcnt lgkmcnt(8)
    v_mfma_f32_32x32x16_bf16 v[224:239], v[100:103], v[144:147], v[224:239]
    ds_read_b64_tr_b16 v[96:97], v11 offset:40960
    ds_read_b64_tr_b16 v[98:99], v11 offset:43008
    s_waitcnt lgkmcnt(8)
    v_mfma_f32_32x32x16_bf16 v[176:191], v[80:83], v[148:151], v[176:191]
    ds_read_b64_tr_b16 v[100:101], v12 offset:40960
    ds_read_b64_tr_b16 v[102:103], v12 offset:43008
    s_waitcnt lgkmcnt(8)
    v_mfma_f32_32x32x16_bf16 v[192:207], v[84:87], v[148:151], v[192:207]
    ds_read_b64_tr_b16 v[80:81], v13 offset:40960
    ds_read_b64_tr_b16 v[82:83], v13 offset:43008
    s_waitcnt lgkmcnt(8)
    v_mfma_f32_32x32x16_bf16 v[208:223], v[88:91], v[148:151], v[208:223]
    ds_read_b64_tr_b16 v[84:85], v14 offset:40960
    ds_read_b64_tr_b16 v[86:87], v14 offset:43008
    s_waitcnt lgkmcnt(8)
    v_mfma_f32_32x32x16_bf16 v[224:239], v[92:95], v[148:151], v[224:239]
    ds_read_b64_tr_b16 v[88:89], v11 offset:45056
    ds_read_b64_tr_b16 v[90:91], v11 offset:47104
    s_waitcnt lgkmcnt(8)
    v_mfma_f32_32x32x16_bf16 v[176:191], v[96:99], v[152:155], v[176:191]
    ds_read_b64_tr_b16 v[92:93], v12 offset:45056
    ds_read_b64_tr_b16 v[94:95], v12 offset:47104
    s_waitcnt lgkmcnt(8)
    v_mfma_f32_32x32x16_bf16 v[192:207], v[100:103], v[152:155], v[192:207]
    ds_read_b64_tr_b16 v[96:97], v13 offset:45056
    ds_read_b64_tr_b16 v[98:99], v13 offset:47104
    s_waitcnt lgkmcnt(8)
    v_mfma_f32_32x32x16_bf16 v[208:223], v[80:83], v[152:155], v[208:223]
    ds_read_b64_tr_b16 v[100:101], v14 offset:45056
    ds_read_b64_tr_b16 v[102:103], v14 offset:47104
    s_waitcnt lgkmcnt(8)
    v_mfma_f32_32x32x16_bf16 v[224:239], v[84:87], v[152:155], v[224:239]
    ds_read_b64_tr_b16 v[80:81], v11 offset:49152
    ds_read_b64_tr_b16 v[82:83], v11 offset:51200
    s_waitcnt lgkmcnt(8)
    v_mfma_f32_32x32x16_bf16 v[176:191], v[88:91], v[156:159], v[176:191]
    ds_read_b64_tr_b16 v[84:85], v12 offset:49152
    ds_read_b64_tr_b16 v[86:87], v12 offset:51200
    s_waitcnt lgkmcnt(8)
    v_mfma_f32_32x32x16_bf16 v[192:207], v[92:95], v[156:159], v[192:207]
    ds_read_b64_tr_b16 v[88:89], v13 offset:49152
    ds_read_b64_tr_b16 v[90:91], v13 offset:51200
    s_waitcnt lgkmcnt(8)
    v_mfma_f32_32x32x16_bf16 v[208:223], v[96:99], v[156:159], v[208:223]
    ds_read_b64_tr_b16 v[92:93], v14 offset:49152
    ds_read_b64_tr_b16 v[94:95], v14 offset:51200
    s_waitcnt lgkmcnt(8)
    v_mfma_f32_32x32x16_bf16 v[224:239], v[100:103], v[156:159], v[224:239]
    ds_read_b64_tr_b16 v[96:97], v11 offset:53248
    ds_read_b64_tr_b16 v[98:99], v11 offset:55296
    s_waitcnt lgkmcnt(8)
    v_mfma_f32_32x32x16_bf16 v[176:191], v[80:83], v[160:163], v[176:191]
    ds_read_b64_tr_b16 v[100:101], v12 offset:53248
    ds_read_b64_tr_b16 v[102:103], v12 offset:55296
    s_waitcnt lgkmcnt(8)
    v_mfma_f32_32x32x16_bf16 v[192:207], v[84:87], v[160:163], v[192:207]
    ds_read_b64_tr_b16 v[80:81], v13 offset:53248
    ds_read_b64_tr_b16 v[82:83], v13 offset:55296
    s_waitcnt lgkmcnt(8)
    v_mfma_f32_32x32x16_bf16 v[208:223], v[88:91], v[160:163], v[208:223]
    ds_read_b64_tr_b16 v[84:85], v14 offset:53248
    ds_read_b64_tr_b16 v[86:87], v14 offset:55296
    s_waitcnt lgkmcnt(8)
    v_mfma_f32_32x32x16_bf16 v[224:239], v[92:95], v[160:163], v[224:239]
    ds_read_b64_tr_b16 v[88:89], v11 offset:57344
    ds_read_b64_tr_b16 v[90:91], v11 offset:59392
    s_waitcnt lgkmcnt(8)
    v_mfma_f32_32x32x16_bf16 v[176:191], v[96:99], v[164:167], v[176:191]
    ds_read_b64_tr_b16 v[92:93], v12 offset:57344
    ds_read_b64_tr_b16 v[94:95], v12 offset:59392
    s_waitcnt lgkmcnt(8)
    v_mfma_f32_32x32x16_bf16 v[192:207], v[100:103], v[164:167], v[192:207]
    ds_read_b64_tr_b16 v[96:97], v13 offset:57344
    ds_read_b64_tr_b16 v[98:99], v13 offset:59392
    s_waitcnt lgkmcnt(8)
    v_mfma_f32_32x32x16_bf16 v[208:223], v[80:83], v[164:167], v[208:223]
    ds_read_b64_tr_b16 v[100:101], v14 offset:57344
    ds_read_b64_tr_b16 v[102:103], v14 offset:59392
    s_waitcnt lgkmcnt(8)
    v_mfma_f32_32x32x16_bf16 v[224:239], v[84:87], v[164:167], v[224:239]
    ds_read_b64_tr_b16 v[80:81], v11 offset:61440
    ds_read_b64_tr_b16 v[82:83], v11 offset:63488
    s_waitcnt lgkmcnt(8)
    v_mfma_f32_32x32x16_bf16 v[176:191], v[88:91], v[168:171], v[176:191]
    ds_read_b64_tr_b16 v[84:85], v12 offset:61440
    ds_read_b64_tr_b16 v[86:87], v12 offset:63488
    s_waitcnt lgkmcnt(8)
    v_mfma_f32_32x32x16_bf16 v[192:207], v[92:95], v[168:171], v[192:207]
    ds_read_b64_tr_b16 v[88:89], v13 offset:61440
    ds_read_b64_tr_b16 v[90:91], v13 offset:63488
    s_waitcnt lgkmcnt(8)
    v_mfma_f32_32x32x16_bf16 v[208:223], v[96:99], v[168:171], v[208:223]
    ds_read_b64_tr_b16 v[92:93], v14 offset:61440
    ds_read_b64_tr_b16 v[94:95], v14 offset:63488
    s_waitcnt lgkmcnt(8)
    v_mfma_f32_32x32x16_bf16 v[224:239], v[100:103], v[168:171], v[224:239]
    s_waitcnt lgkmcnt(6)
    v_mfma_f32_32x32x16_bf16 v[176:191], v[80:83], v[172:175], v[176:191]
    s_waitcnt lgkmcnt(4)
    v_mfma_f32_32x32x16_bf16 v[192:207], v[84:87], v[172:175], v[192:207]
    s_waitcnt lgkmcnt(2)
    v_mfma_f32_32x32x16_bf16 v[208:223], v[88:91], v[172:175], v[208:223]
    s_waitcnt lgkmcnt(0)
    v_mfma_f32_32x32x16_bf16 v[224:239], v[92:95], v[172:175], v[224:239]
    s_nop 7
    s_nop 7
    s_add_u32 s38, s30, 8192
    s_add_u32 s39, s30, 12288
    v_mul_f32 v176, v176, v111
    v_mul_f32 v177, v177, v111
    v_mul_f32 v178, v178, v111
    v_mul_f32 v179, v179, v111
    v_mul_f32 v180, v180, v111
    v_mul_f32 v181, v181, v111
    v_mul_f32 v182, v182, v111
    v_mul_f32 v183, v183, v111
    v_mul_f32 v184, v184, v111
    v_mul_f32 v185, v185, v111
    v_mul_f32 v186, v186, v111
    v_mul_f32 v187, v187, v111
    v_mul_f32 v188, v188, v111
    v_mul_f32 v189, v189, v111
    v_mul_f32 v190, v190, v111
    v_mul_f32 v191, v191, v111
    v_cvt_pk_bf16_f32 v176, v176, v177
    v_cvt_pk_bf16_f32 v177, v178, v179
    v_cvt_pk_bf16_f32 v178, v180, v181
    v_cvt_pk_bf16_f32 v179, v182, v183
    v_cvt_pk_bf16_f32 v180, v184, v185
    v_cvt_pk_bf16_f32 v181, v186, v187
    v_cvt_pk_bf16_f32 v182, v188, v189
    v_cvt_pk_bf16_f32 v183, v190, v191
    ds_write_b128 v240, v[176:179]
    ds_write_b128 v241, v[180:183]
    v_mul_f32 v192, v192, v111
    v_mul_f32 v193, v193, v111
    v_mul_f32 v194, v194, v111
    v_mul_f32 v195, v195, v111
    v_mul_f32 v196, v196, v111
    v_mul_f32 v197, v197, v111
    v_mul_f32 v198, v198, v111
    v_mul_f32 v199, v199, v111
    v_mul_f32 v200, v200, v111
    v_mul_f32 v201, v201, v111
    v_mul_f32 v202, v202, v111
    v_mul_f32 v203, v203, v111
    v_mul_f32 v204, v204, v111
    v_mul_f32 v205, v205, v111
    v_mul_f32 v206, v206, v111
    v_mul_f32 v207, v207, v111
    v_cvt_pk_bf16_f32 v192, v192, v193
    v_cvt_pk_bf16_f32 v193, v194, v195
    v_cvt_pk_bf16_f32 v194, v196, v197
    v_cvt_pk_bf16_f32 v195, v198, v199
    v_cvt_pk_bf16_f32 v196, v200, v201
    v_cvt_pk_bf16_f32 v197, v202, v203
    v_cvt_pk_bf16_f32 v198, v204, v205
    v_cvt_pk_bf16_f32 v199, v206, v207
    ds_write_b128 v242, v[192:195]
    ds_write_b128 v243, v[196:199]
    s_waitcnt lgkmcnt(0)
    ds_read_b128 v[80:83], v2 offset:0
    ds_read_b128 v[84:87], v2 offset:1024
    ds_read_b128 v[88:91], v2 offset:2048
    ds_read_b128 v[92:95], v2 offset:3072
    s_waitcnt lgkmcnt(3)
    buffer_store_dwordx4 v[80:83], v244, s[24:27], s38 offen offset:0
    s_waitcnt lgkmcnt(2)
    buffer_store_dwordx4 v[84:87], v244, s[24:27], s38 offen offset:2048
    s_waitcnt lgkmcnt(1)
    buffer_store_dwordx4 v[88:91], v244, s[24:27], s39 offen offset:0
    s_waitcnt lgkmcnt(0)
    buffer_store_dwordx4 v[92:95], v244, s[24:27], s39 offen offset:2048
    v_mul_f32 v208, v208, v111
    v_mul_f32 v209, v209, v111
    v_mul_f32 v210, v210, v111
    v_mul_f32 v211, v211, v111
    v_mul_f32 v212, v212, v111
    v_mul_f32 v213, v213, v111
    v_mul_f32 v214, v214, v111
    v_mul_f32 v215, v215, v111
    v_mul_f32 v216, v216, v111
    v_mul_f32 v217, v217, v111
    v_mul_f32 v218, v218, v111
    v_mul_f32 v219, v219, v111
    v_mul_f32 v220, v220, v111
    v_mul_f32 v221, v221, v111
    v_mul_f32 v222, v222, v111
    v_mul_f32 v223, v223, v111
    v_cvt_pk_bf16_f32 v208, v208, v209
    v_cvt_pk_bf16_f32 v209, v210, v211
    v_cvt_pk_bf16_f32 v210, v212, v213
    v_cvt_pk_bf16_f32 v211, v214, v215
    v_cvt_pk_bf16_f32 v212, v216, v217
    v_cvt_pk_bf16_f32 v213, v218, v219
    v_cvt_pk_bf16_f32 v214, v220, v221
    v_cvt_pk_bf16_f32 v215, v222, v223
    ds_write_b128 v240, v[208:211]
    ds_write_b128 v241, v[212:215]
    v_mul_f32 v224, v224, v111
    v_mul_f32 v225, v225, v111
    v_mul_f32 v226, v226, v111
    v_mul_f32 v227, v227, v111
    v_mul_f32 v228, v228, v111
    v_mul_f32 v229, v229, v111
    v_mul_f32 v230, v230, v111
    v_mul_f32 v231, v231, v111
    v_mul_f32 v232, v232, v111
    v_mul_f32 v233, v233, v111
    v_mul_f32 v234, v234, v111
    v_mul_f32 v235, v235, v111
    v_mul_f32 v236, v236, v111
    v_mul_f32 v237, v237, v111
    v_mul_f32 v238, v238, v111
    v_mul_f32 v239, v239, v111
    v_cvt_pk_bf16_f32 v224, v224, v225
    v_cvt_pk_bf16_f32 v225, v226, v227
    v_cvt_pk_bf16_f32 v226, v228, v229
    v_cvt_pk_bf16_f32 v227, v230, v231
    v_cvt_pk_bf16_f32 v228, v232, v233
    v_cvt_pk_bf16_f32 v229, v234, v235
    v_cvt_pk_bf16_f32 v230, v236, v237
    v_cvt_pk_bf16_f32 v231, v238, v239
    ds_write_b128 v242, v[224:227]
    ds_write_b128 v243, v[228:231]
    s_waitcnt lgkmcnt(0)
    ds_read_b128 v[80:83], v2 offset:0
    ds_read_b128 v[84:87], v2 offset:1024
    ds_read_b128 v[88:91], v2 offset:2048
    ds_read_b128 v[92:95], v2 offset:3072
    s_waitcnt lgkmcnt(3)
    buffer_store_dwordx4 v[80:83], v244, s[24:27], s38 offen offset:128
    s_waitcnt lgkmcnt(2)
    buffer_store_dwordx4 v[84:87], v244, s[24:27], s38 offen offset:2176
    s_waitcnt lgkmcnt(1)
    buffer_store_dwordx4 v[88:91], v244, s[24:27], s39 offen offset:128
    s_waitcnt lgkmcnt(0)
    buffer_store_dwordx4 v[92:95], v244, s[24:27], s39 offen offset:2176
    s_waitcnt vmcnt(24)
    ds_read_b128 v[80:83], v3 offset:0
    ds_read_b128 v[84:87], v4 offset:0
    ds_read_b128 v[88:91], v5 offset:0
    ds_read_b128 v[92:95], v6 offset:0
    ds_read_b128 v[96:99], v7 offset:0
    s_waitcnt lgkmcnt(4)
    v_mfma_f32_32x32x16_bf16 v[112:127], v[80:83], v[16:19], 0
    ds_read_b128 v[100:103], v8 offset:0
    s_waitcnt lgkmcnt(4)
    v_mfma_f32_32x32x16_bf16 v[112:127], v[84:87], v[20:23], v[112:127]
    ds_read_b128 v[80:83], v9 offset:0
    s_waitcnt lgkmcnt(4)
    v_mfma_f32_32x32x16_bf16 v[112:127], v[88:91], v[24:27], v[112:127]
    ds_read_b128 v[84:87], v10 offset:0
    s_waitcnt lgkmcnt(4)
    v_mfma_f32_32x32x16_bf16 v[112:127], v[92:95], v[28:31], v[112:127]
    ds_read_b128 v[88:91], v3 offset:8192
    s_waitcnt lgkmcnt(4)
    v_mfma_f32_32x32x16_bf16 v[112:127], v[96:99], v[32:35], v[112:127]
    ds_read_b128 v[92:95], v4 offset:8192
    s_waitcnt lgkmcnt(4)
    v_mfma_f32_32x32x16_bf16 v[112:127], v[100:103], v[36:39], v[112:127]
    ds_read_b128 v[96:99], v5 offset:8192
    s_waitcnt lgkmcnt(4)
    v_mfma_f32_32x32x16_bf16 v[112:127], v[80:83], v[40:43], v[112:127]
    ds_read_b128 v[100:103], v6 offset:8192
    s_waitcnt lgkmcnt(4)
    v_mfma_f32_32x32x16_bf16 v[112:127], v[84:87], v[44:47], v[112:127]
    ds_read_b128 v[80:83], v7 offset:8192
    s_waitcnt lgkmcnt(4)
    v_mfma_f32_32x32x16_bf16 v[128:143], v[88:91], v[16:19], 0
    ds_read_b128 v[84:87], v8 offset:8192
    s_waitcnt lgkmcnt(4)
    v_mfma_f32_32x32x16_bf16 v[128:143], v[92:95], v[20:23], v[128:143]
    ds_read_b128 v[88:91], v9 offset:8192
    s_waitcnt lgkmcnt(4)
    v_mfma_f32_32x32x16_bf16 v[128:143], v[96:99], v[24:27], v[128:143]
    ds_read_b128 v[92:95], v10 offset:8192
    s_waitcnt lgkmcnt(4)
    v_mfma_f32_32x32x16_bf16 v[128:143], v[100:103], v[28:31], v[128:143]
    ds_read_b128 v[96:99], v3 offset:16384
    s_waitcnt lgkmcnt(4)
    v_mfma_f32_32x32x16_bf16 v[128:143], v[80:83], v[32:35], v[128:143]
    ds_read_b128 v[100:103], v4 offset:16384
    s_waitcnt lgkmcnt(4)
    v_mfma_f32_32x32x16_bf16 v[128:143], v[84:87], v[36:39], v[128:143]
    ds_read_b128 v[80:83], v5 offset:16384
    s_waitcnt lgkmcnt(4)
    v_mfma_f32_32x32x16_bf16 v[128:143], v[88:91], v[40:43], v[128:143]
    ds_read_b128 v[84:87], v6 offset:16384
    s_waitcnt lgkmcnt(4)
    v_mfma_f32_32x32x16_bf16 v[128:143], v[92:95], v[44:47], v[128:143]
    ds_read_b128 v[88:91], v7 offset:16384
    s_waitcnt lgkmcnt(4)
    v_mfma_f32_32x32x16_bf16 v[144:159], v[96:99], v[16:19], 0
    ds_read_b128 v[92:95], v8 offset:16384
    s_waitcnt lgkmcnt(4)
    v_mfma_f32_32x32x16_bf16 v[144:159], v[100:103], v[20:23], v[144:159]
    ds_read_b128 v[96:99], v9 offset:16384
    s_waitcnt lgkmcnt(4)
    v_mfma_f32_32x32x16_bf16 v[144:159], v[80:83], v[24:27], v[144:159]
    ds_read_b128 v[100:103], v10 offset:16384
    s_waitcnt lgkmcnt(4)
    v_mfma_f32_32x32x16_bf16 v[144:159], v[84:87], v[28:31], v[144:159]
    ds_read_b128 v[80:83], v3 offset:24576
    s_waitcnt lgkmcnt(4)
    v_mfma_f32_32x32x16_bf16 v[144:159], v[88:91], v[32:35], v[144:159]
    ds_read_b128 v[84:87], v4 offset:24576
    s_waitcnt lgkmcnt(4)
    v_mfma_f32_32x32x16_bf16 v[144:159], v[92:95], v[36:39], v[144:159]
    ds_read_b128 v[88:91], v5 offset:24576
    s_waitcnt lgkmcnt(4)
    v_mfma_f32_32x32x16_bf16 v[144:159], v[96:99], v[40:43], v[144:159]
    ds_read_b128 v[92:95], v6 offset:24576
    s_waitcnt lgkmcnt(4)
    v_mfma_f32_32x32x16_bf16 v[144:159], v[100:103], v[44:47], v[144:159]
    ds_read_b128 v[96:99], v7 offset:24576
    s_waitcnt lgkmcnt(4)
    v_mfma_f32_32x32x16_bf16 v[160:175], v[80:83], v[16:19], 0
    ds_read_b128 v[100:103], v8 offset:24576
    s_waitcnt lgkmcnt(4)
    v_mfma_f32_32x32x16_bf16 v[160:175], v[84:87], v[20:23], v[160:175]
    ds_read_b128 v[80:83], v9 offset:24576
    s_waitcnt lgkmcnt(4)
    v_mfma_f32_32x32x16_bf16 v[160:175], v[88:91], v[24:27], v[160:175]
    ds_read_b128 v[84:87], v10 offset:24576
    s_waitcnt lgkmcnt(4)
    v_mfma_f32_32x32x16_bf16 v[160:175], v[92:95], v[28:31], v[160:175]
    ds_read_b128 v[88:91], v3 offset:32768
    s_waitcnt lgkmcnt(4)
    v_mfma_f32_32x32x16_bf16 v[160:175], v[96:99], v[32:35], v[160:175]
    ds_read_b128 v[92:95], v4 offset:32768
    s_waitcnt lgkmcnt(4)
    v_mfma_f32_32x32x16_bf16 v[160:175], v[100:103], v[36:39], v[160:175]
    ds_read_b128 v[96:99], v5 offset:32768
    s_waitcnt lgkmcnt(4)
    v_mfma_f32_32x32x16_bf16 v[160:175], v[80:83], v[40:43], v[160:175]
    ds_read_b128 v[100:103], v6 offset:32768
    s_waitcnt lgkmcnt(4)
    v_mfma_f32_32x32x16_bf16 v[160:175], v[84:87], v[44:47], v[160:175]
    ds_read_b128 v[80:83], v7 offset:32768
    s_waitcnt lgkmcnt(4)
    v_mfma_f32_32x32x16_bf16 v[176:191], v[88:91], v[16:19], 0
    ds_read_b128 v[84:87], v8 offset:32768
    s_waitcnt lgkmcnt(4)
    v_mfma_f32_32x32x16_bf16 v[176:191], v[92:95], v[20:23], v[176:191]
    ds_read_b128 v[88:91], v9 offset:32768
    s_waitcnt lgkmcnt(4)
    v_mfma_f32_32x32x16_bf16 v[176:191], v[96:99], v[24:27], v[176:191]
    ds_read_b128 v[92:95], v10 offset:32768
    s_waitcnt lgkmcnt(4)
    v_mfma_f32_32x32x16_bf16 v[176:191], v[100:103], v[28:31], v[176:191]
    ds_read_b128 v[96:99], v3 offset:40960
    s_waitcnt lgkmcnt(4)
    v_mfma_f32_32x32x16_bf16 v[176:191], v[80:83], v[32:35], v[176:191]
    ds_read_b128 v[100:103], v4 offset:40960
    s_waitcnt lgkmcnt(4)
    v_mfma_f32_32x32x16_bf16 v[176:191], v[84:87], v[36:39], v[176:191]
    ds_read_b128 v[80:83], v5 offset:40960
    s_waitcnt lgkmcnt(4)
    v_mfma_f32_32x32x16_bf16 v[176:191], v[88:91], v[40:43], v[176:191]
    ds_read_b128 v[84:87], v6 offset:40960
    s_waitcnt lgkmcnt(4)
    v_mfma_f32_32x32x16_bf16 v[176:191], v[92:95], v[44:47], v[176:191]
    ds_read_b128 v[88:91], v7 offset:40960
    s_waitcnt lgkmcnt(4)
    v_mfma_f32_32x32x16_bf16 v[192:207], v[96:99], v[16:19], 0
    ds_read_b128 v[92:95], v8 offset:40960
    s_waitcnt lgkmcnt(4)
    v_mfma_f32_32x32x16_bf16 v[192:207], v[100:103], v[20:23], v[192:207]
    ds_read_b128 v[96:99], v9 offset:40960
    s_waitcnt lgkmcnt(4)
    v_mfma_f32_32x32x16_bf16 v[192:207], v[80:83], v[24:27], v[192:207]
    ds_read_b128 v[100:103], v10 offset:40960
    s_waitcnt lgkmcnt(4)
    v_mfma_f32_32x32x16_bf16 v[192:207], v[84:87], v[28:31], v[192:207]
    ds_read_b128 v[80:83], v3 offset:49152
    s_waitcnt lgkmcnt(4)
    v_mfma_f32_32x32x16_bf16 v[192:207], v[88:91], v[32:35], v[192:207]
    ds_read_b128 v[84:87], v4 offset:49152
    s_waitcnt lgkmcnt(4)
    v_mfma_f32_32x32x16_bf16 v[192:207], v[92:95], v[36:39], v[192:207]
    ds_read_b128 v[88:91], v5 offset:49152
    s_waitcnt lgkmcnt(4)
    v_mfma_f32_32x32x16_bf16 v[192:207], v[96:99], v[40:43], v[192:207]
    ds_read_b128 v[92:95], v6 offset:49152
    s_waitcnt lgkmcnt(4)
    v_mfma_f32_32x32x16_bf16 v[192:207], v[100:103], v[44:47], v[192:207]
    ds_read_b128 v[96:99], v7 offset:49152
    s_waitcnt lgkmcnt(4)
    v_mfma_f32_32x32x16_bf16 v[208:223], v[80:83], v[16:19], 0
    ds_read_b128 v[100:103], v8 offset:49152
    s_waitcnt lgkmcnt(4)
    v_mfma_f32_32x32x16_bf16 v[208:223], v[84:87], v[20:23], v[208:223]
    ds_read_b128 v[80:83], v9 offset:49152
    s_waitcnt lgkmcnt(4)
    v_mfma_f32_32x32x16_bf16 v[208:223], v[88:91], v[24:27], v[208:223]
    ds_read_b128 v[84:87], v10 offset:49152
    s_waitcnt lgkmcnt(4)
    v_mfma_f32_32x32x16_bf16 v[208:223], v[92:95], v[28:31], v[208:223]
    ds_read_b128 v[88:91], v3 offset:57344
    s_waitcnt lgkmcnt(4)
    v_mfma_f32_32x32x16_bf16 v[208:223], v[96:99], v[32:35], v[208:223]
    ds_read_b128 v[92:95], v4 offset:57344
    s_waitcnt lgkmcnt(4)
    v_mfma_f32_32x32x16_bf16 v[208:223], v[100:103], v[36:39], v[208:223]
    ds_read_b128 v[96:99], v5 offset:57344
    s_waitcnt lgkmcnt(4)
    v_mfma_f32_32x32x16_bf16 v[208:223], v[80:83], v[40:43], v[208:223]
    ds_read_b128 v[100:103], v6 offset:57344
    s_waitcnt lgkmcnt(4)
    v_mfma_f32_32x32x16_bf16 v[208:223], v[84:87], v[44:47], v[208:223]
    ds_read_b128 v[80:83], v7 offset:57344
    s_waitcnt lgkmcnt(4)
    v_mfma_f32_32x32x16_bf16 v[224:239], v[88:91], v[16:19], 0
    ds_read_b128 v[84:87], v8 offset:57344
    s_waitcnt lgkmcnt(4)
    v_mfma_f32_32x32x16_bf16 v[224:239], v[92:95], v[20:23], v[224:239]
    ds_read_b128 v[88:91], v9 offset:57344
    s_waitcnt lgkmcnt(4)
    v_mfma_f32_32x32x16_bf16 v[224:239], v[96:99], v[24:27], v[224:239]
    ds_read_b128 v[92:95], v10 offset:57344
    s_waitcnt lgkmcnt(4)
    v_mfma_f32_32x32x16_bf16 v[224:239], v[100:103], v[28:31], v[224:239]
    s_waitcnt lgkmcnt(3)
    v_mfma_f32_32x32x16_bf16 v[224:239], v[80:83], v[32:35], v[224:239]
    s_waitcnt lgkmcnt(2)
    v_mfma_f32_32x32x16_bf16 v[224:239], v[84:87], v[36:39], v[224:239]
    s_waitcnt lgkmcnt(1)
    v_mfma_f32_32x32x16_bf16 v[224:239], v[88:91], v[40:43], v[224:239]
    s_waitcnt lgkmcnt(0)
    v_mfma_f32_32x32x16_bf16 v[224:239], v[92:95], v[44:47], v[224:239]
    s_add_u32 s34, s30, 0x4000000
    buffer_load_dwordx4 v[16:19], v1, s[12:15], s34 offen offset:0
    buffer_load_dwordx4 v[20:23], v1, s[12:15], s34 offen offset:32
    buffer_load_dwordx4 v[24:27], v1, s[12:15], s34 offen offset:64
    buffer_load_dwordx4 v[28:31], v1, s[12:15], s34 offen offset:96
    buffer_load_dwordx4 v[32:35], v1, s[12:15], s34 offen offset:128
    buffer_load_dwordx4 v[36:39], v1, s[12:15], s34 offen offset:160
    buffer_load_dwordx4 v[40:43], v1, s[12:15], s34 offen offset:192
    buffer_load_dwordx4 v[44:47], v1, s[12:15], s34 offen offset:224
    s_nop 7
    v_max3_f32 v104, v112, v113, v114
    v_max3_f32 v106, v115, v116, v117
    v_max3_f32 v104, v104, v118, v119
    v_max3_f32 v106, v106, v120, v121
    v_max3_f32 v104, v104, v122, v123
    v_max3_f32 v106, v106, v124, v125
    v_max3_f32 v104, v104, v126, v127
    v_max3_f32 v106, v106, v128, v129
    v_max3_f32 v104, v104, v130, v131
    v_max3_f32 v106, v106, v132, v133
    v_max3_f32 v104, v104, v134, v135
    v_max3_f32 v106, v106, v136, v137
    v_max3_f32 v104, v104, v138, v139
    v_max3_f32 v106, v106, v140, v141
    v_max3_f32 v104, v104, v142, v143
    v_max3_f32 v106, v106, v144, v145
    v_max3_f32 v104, v104, v146, v147
    v_max3_f32 v106, v106, v148, v149
    v_max3_f32 v104, v104, v150, v151
    v_max3_f32 v106, v106, v152, v153
    v_max3_f32 v104, v104, v154, v155
    v_max3_f32 v106, v106, v156, v157
    v_max3_f32 v104, v104, v158, v159
    v_max3_f32 v106, v106, v160, v161
    v_max3_f32 v104, v104, v162, v163
    v_max3_f32 v106, v106, v164, v165
    v_max3_f32 v104, v104, v166, v167
    v_max3_f32 v106, v106, v168, v169
    v_max3_f32 v104, v104, v170, v171
    v_max3_f32 v106, v106, v172, v173
    v_max3_f32 v104, v104, v174, v175
    v_max3_f32 v106, v106, v176, v177
    v_max3_f32 v104, v104, v178, v179
    v_max3_f32 v106, v106, v180, v181
    v_max3_f32 v104, v104, v182, v183
    v_max3_f32 v106, v106, v184, v185
    v_max3_f32 v104, v104, v186, v187
    v_max3_f32 v106, v106, v188, v189
    v_max3_f32 v104, v104, v190, v191
    v_max3_f32 v106, v106, v192, v193
    v_max3_f32 v104, v104, v194, v195
    v_max3_f32 v106, v106, v196, v197
    v_max3_f32 v104, v104, v198, v199
    v_max3_f32 v106, v106, v200, v201
    v_max3_f32 v104, v104, v202, v203
    v_max3_f32 v106, v106, v204, v205
    v_max3_f32 v104, v104, v206, v207
    v_max3_f32 v106, v106, v208, v209
    v_max3_f32 v104, v104, v210, v211
    v_max3_f32 v106, v106, v212, v213
    v_max3_f32 v104, v104, v214, v215
    v_max3_f32 v106, v106, v216, v217
    v_max3_f32 v104, v104, v218, v219
    v_max3_f32 v106, v106, v220, v221
    v_max3_f32 v104, v104, v222, v223
    v_max3_f32 v106, v106, v224, v225
    v_max3_f32 v104, v104, v226, v227
    v_max3_f32 v106, v106, v228, v229
    v_max3_f32 v104, v104, v230, v231
    v_max3_f32 v106, v106, v232, v233
    v_max3_f32 v104, v104, v234, v235
    v_max3_f32 v106, v106, v236, v237
    v_max3_f32 v104, v104, v238, v239
    v_max_f32 v104, v104, v106
    v_mov_b32 v106, v104
    s_nop 1
    v_permlane32_swap_b32 v104, v106
    v_max_f32 v104, v104, v106
    v_mul_f32 v105, s32, v104
    v_mov_b32 v107, 0
    v_mov_b32 v108, 0
    v_mov_b32 v109, 0
    v_mov_b32 v110, 0
    v_fma_f32 v112, v112, s32, -v105
    v_fma_f32 v113, v113, s32, -v105
    v_fma_f32 v114, v114, s32, -v105
    v_fma_f32 v115, v115, s32, -v105
    v_exp_f32 v112, v112
    v_exp_f32 v113, v113
    v_exp_f32 v114, v114
    v_exp_f32 v115, v115
    s_nop 0
    v_add_f32 v107, v107, v112
    v_add_f32 v108, v108, v113
    v_add_f32 v109, v109, v114
    v_add_f32 v110, v110, v115
    v_cvt_pk_bf16_f32 v112, v112, v113
    v_cvt_pk_bf16_f32 v113, v114, v115
    v_fma_f32 v116, v116, s32, -v105
    v_fma_f32 v117, v117, s32, -v105
    v_fma_f32 v118, v118, s32, -v105
    v_fma_f32 v119, v119, s32, -v105
    v_exp_f32 v116, v116
    v_exp_f32 v117, v117
    v_exp_f32 v118, v118
    v_exp_f32 v119, v119
    s_nop 0
    v_add_f32 v107, v107, v116
    v_add_f32 v108, v108, v117
    v_add_f32 v109, v109, v118
    v_add_f32 v110, v110, v119
    v_cvt_pk_bf16_f32 v114, v116, v117
    v_cvt_pk_bf16_f32 v115, v118, v119
    v_fma_f32 v120, v120, s32, -v105
    v_fma_f32 v121, v121, s32, -v105
    v_fma_f32 v122, v122, s32, -v105
    v_fma_f32 v123, v123, s32, -v105
    v_exp_f32 v120, v120
    v_exp_f32 v121, v121
    v_exp_f32 v122, v122
    v_exp_f32 v123, v123
    s_nop 0
    v_add_f32 v107, v107, v120
    v_add_f32 v108, v108, v121
    v_add_f32 v109, v109, v122
    v_add_f32 v110, v110, v123
    v_cvt_pk_bf16_f32 v116, v120, v121
    v_cvt_pk_bf16_f32 v117, v122, v123
    v_fma_f32 v124, v124, s32, -v105
    v_fma_f32 v125, v125, s32, -v105
    v_fma_f32 v126, v126, s32, -v105
    v_fma_f32 v127, v127, s32, -v105
    v_exp_f32 v124, v124
    v_exp_f32 v125, v125
    v_exp_f32 v126, v126
    v_exp_f32 v127, v127
    s_nop 0
    v_add_f32 v107, v107, v124
    v_add_f32 v108, v108, v125
    v_add_f32 v109, v109, v126
    v_add_f32 v110, v110, v127
    v_cvt_pk_bf16_f32 v118, v124, v125
    v_cvt_pk_bf16_f32 v119, v126, v127
    v_fma_f32 v128, v128, s32, -v105
    v_fma_f32 v129, v129, s32, -v105
    v_fma_f32 v130, v130, s32, -v105
    v_fma_f32 v131, v131, s32, -v105
    v_exp_f32 v128, v128
    v_exp_f32 v129, v129
    v_exp_f32 v130, v130
    v_exp_f32 v131, v131
    s_nop 0
    v_add_f32 v107, v107, v128
    v_add_f32 v108, v108, v129
    v_add_f32 v109, v109, v130
    v_add_f32 v110, v110, v131
    v_cvt_pk_bf16_f32 v120, v128, v129
    v_cvt_pk_bf16_f32 v121, v130, v131
    v_fma_f32 v132, v132, s32, -v105
    v_fma_f32 v133, v133, s32, -v105
    v_fma_f32 v134, v134, s32, -v105
    v_fma_f32 v135, v135, s32, -v105
    v_exp_f32 v132, v132
    v_exp_f32 v133, v133
    v_exp_f32 v134, v134
    v_exp_f32 v135, v135
    s_nop 0
    v_add_f32 v107, v107, v132
    v_add_f32 v108, v108, v133
    v_add_f32 v109, v109, v134
    v_add_f32 v110, v110, v135
    v_cvt_pk_bf16_f32 v122, v132, v133
    v_cvt_pk_bf16_f32 v123, v134, v135
    v_fma_f32 v136, v136, s32, -v105
    v_fma_f32 v137, v137, s32, -v105
    v_fma_f32 v138, v138, s32, -v105
    v_fma_f32 v139, v139, s32, -v105
    v_exp_f32 v136, v136
    v_exp_f32 v137, v137
    v_exp_f32 v138, v138
    v_exp_f32 v139, v139
    s_nop 0
    v_add_f32 v107, v107, v136
    v_add_f32 v108, v108, v137
    v_add_f32 v109, v109, v138
    v_add_f32 v110, v110, v139
    v_cvt_pk_bf16_f32 v124, v136, v137
    v_cvt_pk_bf16_f32 v125, v138, v139
    v_fma_f32 v140, v140, s32, -v105
    v_fma_f32 v141, v141, s32, -v105
    v_fma_f32 v142, v142, s32, -v105
    v_fma_f32 v143, v143, s32, -v105
    v_exp_f32 v140, v140
    v_exp_f32 v141, v141
    v_exp_f32 v142, v142
    v_exp_f32 v143, v143
    s_nop 0
    v_add_f32 v107, v107, v140
    v_add_f32 v108, v108, v141
    v_add_f32 v109, v109, v142
    v_add_f32 v110, v110, v143
    v_cvt_pk_bf16_f32 v126, v140, v141
    v_cvt_pk_bf16_f32 v127, v142, v143
    v_fma_f32 v144, v144, s32, -v105
    v_fma_f32 v145, v145, s32, -v105
    v_fma_f32 v146, v146, s32, -v105
    v_fma_f32 v147, v147, s32, -v105
    v_exp_f32 v144, v144
    v_exp_f32 v145, v145
    v_exp_f32 v146, v146
    v_exp_f32 v147, v147
    s_nop 0
    v_add_f32 v107, v107, v144
    v_add_f32 v108, v108, v145
    v_add_f32 v109, v109, v146
    v_add_f32 v110, v110, v147
    v_cvt_pk_bf16_f32 v128, v144, v145
    v_cvt_pk_bf16_f32 v129, v146, v147
    v_fma_f32 v148, v148, s32, -v105
    v_fma_f32 v149, v149, s32, -v105
    v_fma_f32 v150, v150, s32, -v105
    v_fma_f32 v151, v151, s32, -v105
    v_exp_f32 v148, v148
    v_exp_f32 v149, v149
    v_exp_f32 v150, v150
    v_exp_f32 v151, v151
    s_nop 0
    v_add_f32 v107, v107, v148
    v_add_f32 v108, v108, v149
    v_add_f32 v109, v109, v150
    v_add_f32 v110, v110, v151
    v_cvt_pk_bf16_f32 v130, v148, v149
    v_cvt_pk_bf16_f32 v131, v150, v151
    v_fma_f32 v152, v152, s32, -v105
    v_fma_f32 v153, v153, s32, -v105
    v_fma_f32 v154, v154, s32, -v105
    v_fma_f32 v155, v155, s32, -v105
    v_exp_f32 v152, v152
    v_exp_f32 v153, v153
    v_exp_f32 v154, v154
    v_exp_f32 v155, v155
    s_nop 0
    v_add_f32 v107, v107, v152
    v_add_f32 v108, v108, v153
    v_add_f32 v109, v109, v154
    v_add_f32 v110, v110, v155
    v_cvt_pk_bf16_f32 v132, v152, v153
    v_cvt_pk_bf16_f32 v133, v154, v155
    v_fma_f32 v156, v156, s32, -v105
    v_fma_f32 v157, v157, s32, -v105
    v_fma_f32 v158, v158, s32, -v105
    v_fma_f32 v159, v159, s32, -v105
    v_exp_f32 v156, v156
    v_exp_f32 v157, v157
    v_exp_f32 v158, v158
    v_exp_f32 v159, v159
    s_nop 0
    v_add_f32 v107, v107, v156
    v_add_f32 v108, v108, v157
    v_add_f32 v109, v109, v158
    v_add_f32 v110, v110, v159
    v_cvt_pk_bf16_f32 v134, v156, v157
    v_cvt_pk_bf16_f32 v135, v158, v159
    v_fma_f32 v160, v160, s32, -v105
    v_fma_f32 v161, v161, s32, -v105
    v_fma_f32 v162, v162, s32, -v105
    v_fma_f32 v163, v163, s32, -v105
    v_exp_f32 v160, v160
    v_exp_f32 v161, v161
    v_exp_f32 v162, v162
    v_exp_f32 v163, v163
    s_nop 0
    v_add_f32 v107, v107, v160
    v_add_f32 v108, v108, v161
    v_add_f32 v109, v109, v162
    v_add_f32 v110, v110, v163
    v_cvt_pk_bf16_f32 v136, v160, v161
    v_cvt_pk_bf16_f32 v137, v162, v163
    v_fma_f32 v164, v164, s32, -v105
    v_fma_f32 v165, v165, s32, -v105
    v_fma_f32 v166, v166, s32, -v105
    v_fma_f32 v167, v167, s32, -v105
    v_exp_f32 v164, v164
    v_exp_f32 v165, v165
    v_exp_f32 v166, v166
    v_exp_f32 v167, v167
    s_nop 0
    v_add_f32 v107, v107, v164
    v_add_f32 v108, v108, v165
    v_add_f32 v109, v109, v166
    v_add_f32 v110, v110, v167
    v_cvt_pk_bf16_f32 v138, v164, v165
    v_cvt_pk_bf16_f32 v139, v166, v167
    v_fma_f32 v168, v168, s32, -v105
    v_fma_f32 v169, v169, s32, -v105
    v_fma_f32 v170, v170, s32, -v105
    v_fma_f32 v171, v171, s32, -v105
    v_exp_f32 v168, v168
    v_exp_f32 v169, v169
    v_exp_f32 v170, v170
    v_exp_f32 v171, v171
    s_nop 0
    v_add_f32 v107, v107, v168
    v_add_f32 v108, v108, v169
    v_add_f32 v109, v109, v170
    v_add_f32 v110, v110, v171
    v_cvt_pk_bf16_f32 v140, v168, v169
    v_cvt_pk_bf16_f32 v141, v170, v171
    v_fma_f32 v172, v172, s32, -v105
    v_fma_f32 v173, v173, s32, -v105
    v_fma_f32 v174, v174, s32, -v105
    v_fma_f32 v175, v175, s32, -v105
    v_exp_f32 v172, v172
    v_exp_f32 v173, v173
    v_exp_f32 v174, v174
    v_exp_f32 v175, v175
    s_nop 0
    v_add_f32 v107, v107, v172
    v_add_f32 v108, v108, v173
    v_add_f32 v109, v109, v174
    v_add_f32 v110, v110, v175
    v_cvt_pk_bf16_f32 v142, v172, v173
    v_cvt_pk_bf16_f32 v143, v174, v175
    v_fma_f32 v176, v176, s32, -v105
    v_fma_f32 v177, v177, s32, -v105
    v_fma_f32 v178, v178, s32, -v105
    v_fma_f32 v179, v179, s32, -v105
    v_exp_f32 v176, v176
    v_exp_f32 v177, v177
    v_exp_f32 v178, v178
    v_exp_f32 v179, v179
    s_nop 0
    v_add_f32 v107, v107, v176
    v_add_f32 v108, v108, v177
    v_add_f32 v109, v109, v178
    v_add_f32 v110, v110, v179
    v_cvt_pk_bf16_f32 v144, v176, v177
    v_cvt_pk_bf16_f32 v145, v178, v179
    v_fma_f32 v180, v180, s32, -v105
    v_fma_f32 v181, v181, s32, -v105
    v_fma_f32 v182, v182, s32, -v105
    v_fma_f32 v183, v183, s32, -v105
    v_exp_f32 v180, v180
    v_exp_f32 v181, v181
    v_exp_f32 v182, v182
    v_exp_f32 v183, v183
    s_nop 0
    v_add_f32 v107, v107, v180
    v_add_f32 v108, v108, v181
    v_add_f32 v109, v109, v182
    v_add_f32 v110, v110, v183
    v_cvt_pk_bf16_f32 v146, v180, v181
    v_cvt_pk_bf16_f32 v147, v182, v183
    v_fma_f32 v184, v184, s32, -v105
    v_fma_f32 v185, v185, s32, -v105
    v_fma_f32 v186, v186, s32, -v105
    v_fma_f32 v187, v187, s32, -v105
    v_exp_f32 v184, v184
    v_exp_f32 v185, v185
    v_exp_f32 v186, v186
    v_exp_f32 v187, v187
    s_nop 0
    v_add_f32 v107, v107, v184
    v_add_f32 v108, v108, v185
    v_add_f32 v109, v109, v186
    v_add_f32 v110, v110, v187
    v_cvt_pk_bf16_f32 v148, v184, v185
    v_cvt_pk_bf16_f32 v149, v186, v187
    v_fma_f32 v188, v188, s32, -v105
    v_fma_f32 v189, v189, s32, -v105
    v_fma_f32 v190, v190, s32, -v105
    v_fma_f32 v191, v191, s32, -v105
    v_exp_f32 v188, v188
    v_exp_f32 v189, v189
    v_exp_f32 v190, v190
    v_exp_f32 v191, v191
    s_nop 0
    v_add_f32 v107, v107, v188
    v_add_f32 v108, v108, v189
    v_add_f32 v109, v109, v190
    v_add_f32 v110, v110, v191
    v_cvt_pk_bf16_f32 v150, v188, v189
    v_cvt_pk_bf16_f32 v151, v190, v191
    v_fma_f32 v192, v192, s32, -v105
    v_fma_f32 v193, v193, s32, -v105
    v_fma_f32 v194, v194, s32, -v105
    v_fma_f32 v195, v195, s32, -v105
    v_exp_f32 v192, v192
    v_exp_f32 v193, v193
    v_exp_f32 v194, v194
    v_exp_f32 v195, v195
    s_nop 0
    v_add_f32 v107, v107, v192
    v_add_f32 v108, v108, v193
    v_add_f32 v109, v109, v194
    v_add_f32 v110, v110, v195
    v_cvt_pk_bf16_f32 v152, v192, v193
    v_cvt_pk_bf16_f32 v153, v194, v195
    v_fma_f32 v196, v196, s32, -v105
    v_fma_f32 v197, v197, s32, -v105
    v_fma_f32 v198, v198, s32, -v105
    v_fma_f32 v199, v199, s32, -v105
    v_exp_f32 v196, v196
    v_exp_f32 v197, v197
    v_exp_f32 v198, v198
    v_exp_f32 v199, v199
    s_nop 0
    v_add_f32 v107, v107, v196
    v_add_f32 v108, v108, v197
    v_add_f32 v109, v109, v198
    v_add_f32 v110, v110, v199
    v_cvt_pk_bf16_f32 v154, v196, v197
    v_cvt_pk_bf16_f32 v155, v198, v199
    v_fma_f32 v200, v200, s32, -v105
    v_fma_f32 v201, v201, s32, -v105
    v_fma_f32 v202, v202, s32, -v105
    v_fma_f32 v203, v203, s32, -v105
    v_exp_f32 v200, v200
    v_exp_f32 v201, v201
    v_exp_f32 v202, v202
    v_exp_f32 v203, v203
    s_nop 0
    v_add_f32 v107, v107, v200
    v_add_f32 v108, v108, v201
    v_add_f32 v109, v109, v202
    v_add_f32 v110, v110, v203
    v_cvt_pk_bf16_f32 v156, v200, v201
    v_cvt_pk_bf16_f32 v157, v202, v203
    v_fma_f32 v204, v204, s32, -v105
    v_fma_f32 v205, v205, s32, -v105
    v_fma_f32 v206, v206, s32, -v105
    v_fma_f32 v207, v207, s32, -v105
    v_exp_f32 v204, v204
    v_exp_f32 v205, v205
    v_exp_f32 v206, v206
    v_exp_f32 v207, v207
    s_nop 0
    v_add_f32 v107, v107, v204
    v_add_f32 v108, v108, v205
    v_add_f32 v109, v109, v206
    v_add_f32 v110, v110, v207
    v_cvt_pk_bf16_f32 v158, v204, v205
    v_cvt_pk_bf16_f32 v159, v206, v207
    v_fma_f32 v208, v208, s32, -v105
    v_fma_f32 v209, v209, s32, -v105
    v_fma_f32 v210, v210, s32, -v105
    v_fma_f32 v211, v211, s32, -v105
    v_exp_f32 v208, v208
    v_exp_f32 v209, v209
    v_exp_f32 v210, v210
    v_exp_f32 v211, v211
    s_nop 0
    v_add_f32 v107, v107, v208
    v_add_f32 v108, v108, v209
    v_add_f32 v109, v109, v210
    v_add_f32 v110, v110, v211
    v_cvt_pk_bf16_f32 v160, v208, v209
    v_cvt_pk_bf16_f32 v161, v210, v211
    v_fma_f32 v212, v212, s32, -v105
    v_fma_f32 v213, v213, s32, -v105
    v_fma_f32 v214, v214, s32, -v105
    v_fma_f32 v215, v215, s32, -v105
    v_exp_f32 v212, v212
    v_exp_f32 v213, v213
    v_exp_f32 v214, v214
    v_exp_f32 v215, v215
    s_nop 0
    v_add_f32 v107, v107, v212
    v_add_f32 v108, v108, v213
    v_add_f32 v109, v109, v214
    v_add_f32 v110, v110, v215
    v_cvt_pk_bf16_f32 v162, v212, v213
    v_cvt_pk_bf16_f32 v163, v214, v215
    v_fma_f32 v216, v216, s32, -v105
    v_fma_f32 v217, v217, s32, -v105
    v_fma_f32 v218, v218, s32, -v105
    v_fma_f32 v219, v219, s32, -v105
    v_exp_f32 v216, v216
    v_exp_f32 v217, v217
    v_exp_f32 v218, v218
    v_exp_f32 v219, v219
    s_nop 0
    v_add_f32 v107, v107, v216
    v_add_f32 v108, v108, v217
    v_add_f32 v109, v109, v218
    v_add_f32 v110, v110, v219
    v_cvt_pk_bf16_f32 v164, v216, v217
    v_cvt_pk_bf16_f32 v165, v218, v219
    v_fma_f32 v220, v220, s32, -v105
    v_fma_f32 v221, v221, s32, -v105
    v_fma_f32 v222, v222, s32, -v105
    v_fma_f32 v223, v223, s32, -v105
    v_exp_f32 v220, v220
    v_exp_f32 v221, v221
    v_exp_f32 v222, v222
    v_exp_f32 v223, v223
    s_nop 0
    v_add_f32 v107, v107, v220
    v_add_f32 v108, v108, v221
    v_add_f32 v109, v109, v222
    v_add_f32 v110, v110, v223
    v_cvt_pk_bf16_f32 v166, v220, v221
    v_cvt_pk_bf16_f32 v167, v222, v223
    v_fma_f32 v224, v224, s32, -v105
    v_fma_f32 v225, v225, s32, -v105
    v_fma_f32 v226, v226, s32, -v105
    v_fma_f32 v227, v227, s32, -v105
    v_exp_f32 v224, v224
    v_exp_f32 v225, v225
    v_exp_f32 v226, v226
    v_exp_f32 v227, v227
    s_nop 0
    v_add_f32 v107, v107, v224
    v_add_f32 v108, v108, v225
    v_add_f32 v109, v109, v226
    v_add_f32 v110, v110, v227
    v_cvt_pk_bf16_f32 v168, v224, v225
    v_cvt_pk_bf16_f32 v169, v226, v227
    v_fma_f32 v228, v228, s32, -v105
    v_fma_f32 v229, v229, s32, -v105
    v_fma_f32 v230, v230, s32, -v105
    v_fma_f32 v231, v231, s32, -v105
    v_exp_f32 v228, v228
    v_exp_f32 v229, v229
    v_exp_f32 v230, v230
    v_exp_f32 v231, v231
    s_nop 0
    v_add_f32 v107, v107, v228
    v_add_f32 v108, v108, v229
    v_add_f32 v109, v109, v230
    v_add_f32 v110, v110, v231
    v_cvt_pk_bf16_f32 v170, v228, v229
    v_cvt_pk_bf16_f32 v171, v230, v231
    v_fma_f32 v232, v232, s32, -v105
    v_fma_f32 v233, v233, s32, -v105
    v_fma_f32 v234, v234, s32, -v105
    v_fma_f32 v235, v235, s32, -v105
    v_exp_f32 v232, v232
    v_exp_f32 v233, v233
    v_exp_f32 v234, v234
    v_exp_f32 v235, v235
    s_nop 0
    v_add_f32 v107, v107, v232
    v_add_f32 v108, v108, v233
    v_add_f32 v109, v109, v234
    v_add_f32 v110, v110, v235
    v_cvt_pk_bf16_f32 v172, v232, v233
    v_cvt_pk_bf16_f32 v173, v234, v235
    v_fma_f32 v236, v236, s32, -v105
    v_fma_f32 v237, v237, s32, -v105
    v_fma_f32 v238, v238, s32, -v105
    v_fma_f32 v239, v239, s32, -v105
    v_exp_f32 v236, v236
    v_exp_f32 v237, v237
    v_exp_f32 v238, v238
    v_exp_f32 v239, v239
    s_nop 0
    v_add_f32 v107, v107, v236
    v_add_f32 v108, v108, v237
    v_add_f32 v109, v109, v238
    v_add_f32 v110, v110, v239
    v_cvt_pk_bf16_f32 v174, v236, v237
    v_cvt_pk_bf16_f32 v175, v238, v239
    v_add_f32 v107, v107, v108
    v_add_f32 v109, v109, v110
    v_add_f32 v107, v107, v109
    v_mov_b32 v106, v107
    s_nop 1
    v_permlane32_swap_b32 v107, v106
    v_add_f32 v107, v107, v106
    v_rcp_f32 v111, v107
    ds_read_b64_tr_b16 v[80:81], v11 offset:0
    ds_read_b64_tr_b16 v[82:83], v11 offset:2048
    ds_read_b64_tr_b16 v[84:85], v12 offset:0
    ds_read_b64_tr_b16 v[86:87], v12 offset:2048
    ds_read_b64_tr_b16 v[88:89], v13 offset:0
    ds_read_b64_tr_b16 v[90:91], v13 offset:2048
    ds_read_b64_tr_b16 v[92:93], v14 offset:0
    ds_read_b64_tr_b16 v[94:95], v14 offset:2048
    ds_read_b64_tr_b16 v[96:97], v11 offset:4096
    ds_read_b64_tr_b16 v[98:99], v11 offset:6144
    s_waitcnt lgkmcnt(8)
    v_mfma_f32_32x32x16_bf16 v[176:191], v[80:83], v[112:115], 0
    ds_read_b64_tr_b16 v[100:101], v12 offset:4096
    ds_read_b64_tr_b16 v[102:103], v12 offset:6144
    s_waitcnt lgkmcnt(8)
    v_mfma_f32_32x32x16_bf16 v[192:207], v[84:87], v[112:115], 0
    ds_read_b64_tr_b16 v[80:81], v13 offset:4096
    ds_read_b64_tr_b16 v[82:83], v13 offset:6144
    s_waitcnt lgkmcnt(8)
    v_mfma_f32_32x32x16_bf16 v[208:223], v[88:91], v[112:115], 0
    ds_read_b64_tr_b16 v[84:85], v14 offset:4096
    ds_read_b64_tr_b16 v[86:87], v14 offset:6144
    s_waitcnt lgkmcnt(8)
    v_mfma_f32_32x32x16_bf16 v[224:239], v[92:95], v[112:115], 0
    ds_read_b64_tr_b16 v[88:89], v11 offset:8192
    ds_read_b64_tr_b16 v[90:91], v11 offset:10240
    s_waitcnt lgkmcnt(8)
    v_mfma_f32_32x32x16_bf16 v[176:191], v[96:99], v[116:119], v[176:191]
    ds_read_b64_tr_b16 v[92:93], v12 offset:8192
    ds_read_b64_tr_b16 v[94:95], v12 offset:10240
    s_waitcnt lgkmcnt(8)
    v_mfma_f32_32x32x16_bf16 v[192:207], v[100:103], v[116:119], v[192:207]
    ds_read_b64_tr_b16 v[96:97], v13 offset:8192
    ds_read_b64_tr_b16 v[98:99], v13 offset:10240
    s_waitcnt lgkmcnt(8)
    v_mfma_f32_32x32x16_bf16 v[208:223], v[80:83], v[116:119], v[208:223]
    ds_read_b64_tr_b16 v[100:101], v14 offset:8192
    ds_read_b64_tr_b16 v[102:103], v14 offset:10240
    s_waitcnt lgkmcnt(8)
    v_mfma_f32_32x32x16_bf16 v[224:239], v[84:87], v[116:119], v[224:239]
    ds_read_b64_tr_b16 v[80:81], v11 offset:12288
    ds_read_b64_tr_b16 v[82:83], v11 offset:14336
    s_waitcnt lgkmcnt(8)
    v_mfma_f32_32x32x16_bf16 v[176:191], v[88:91], v[120:123], v[176:191]
    ds_read_b64_tr_b16 v[84:85], v12 offset:12288
    ds_read_b64_tr_b16 v[86:87], v12 offset:14336
    s_waitcnt lgkmcnt(8)
    v_mfma_f32_32x32x16_bf16 v[192:207], v[92:95], v[120:123], v[192:207]
    ds_read_b64_tr_b16 v[88:89], v13 offset:12288
    ds_read_b64_tr_b16 v[90:91], v13 offset:14336
    s_waitcnt lgkmcnt(8)
    v_mfma_f32_32x32x16_bf16 v[208:223], v[96:99], v[120:123], v[208:223]
    ds_read_b64_tr_b16 v[92:93], v14 offset:12288
    ds_read_b64_tr_b16 v[94:95], v14 offset:14336
    s_waitcnt lgkmcnt(8)
    v_mfma_f32_32x32x16_bf16 v[224:239], v[100:103], v[120:123], v[224:239]
    ds_read_b64_tr_b16 v[96:97], v11 offset:16384
    ds_read_b64_tr_b16 v[98:99], v11 offset:18432
    s_waitcnt lgkmcnt(8)
    v_mfma_f32_32x32x16_bf16 v[176:191], v[80:83], v[124:127], v[176:191]
    ds_read_b64_tr_b16 v[100:101], v12 offset:16384
    ds_read_b64_tr_b16 v[102:103], v12 offset:18432
    s_waitcnt lgkmcnt(8)
    v_mfma_f32_32x32x16_bf16 v[192:207], v[84:87], v[124:127], v[192:207]
    ds_read_b64_tr_b16 v[80:81], v13 offset:16384
    ds_read_b64_tr_b16 v[82:83], v13 offset:18432
    s_waitcnt lgkmcnt(8)
    v_mfma_f32_32x32x16_bf16 v[208:223], v[88:91], v[124:127], v[208:223]
    ds_read_b64_tr_b16 v[84:85], v14 offset:16384
    ds_read_b64_tr_b16 v[86:87], v14 offset:18432
    s_waitcnt lgkmcnt(8)
    v_mfma_f32_32x32x16_bf16 v[224:239], v[92:95], v[124:127], v[224:239]
    ds_read_b64_tr_b16 v[88:89], v11 offset:20480
    ds_read_b64_tr_b16 v[90:91], v11 offset:22528
    s_waitcnt lgkmcnt(8)
    v_mfma_f32_32x32x16_bf16 v[176:191], v[96:99], v[128:131], v[176:191]
    ds_read_b64_tr_b16 v[92:93], v12 offset:20480
    ds_read_b64_tr_b16 v[94:95], v12 offset:22528
    s_waitcnt lgkmcnt(8)
    v_mfma_f32_32x32x16_bf16 v[192:207], v[100:103], v[128:131], v[192:207]
    ds_read_b64_tr_b16 v[96:97], v13 offset:20480
    ds_read_b64_tr_b16 v[98:99], v13 offset:22528
    s_waitcnt lgkmcnt(8)
    v_mfma_f32_32x32x16_bf16 v[208:223], v[80:83], v[128:131], v[208:223]
    ds_read_b64_tr_b16 v[100:101], v14 offset:20480
    ds_read_b64_tr_b16 v[102:103], v14 offset:22528
    s_waitcnt lgkmcnt(8)
    v_mfma_f32_32x32x16_bf16 v[224:239], v[84:87], v[128:131], v[224:239]
    ds_read_b64_tr_b16 v[80:81], v11 offset:24576
    ds_read_b64_tr_b16 v[82:83], v11 offset:26624
    s_waitcnt lgkmcnt(8)
    v_mfma_f32_32x32x16_bf16 v[176:191], v[88:91], v[132:135], v[176:191]
    ds_read_b64_tr_b16 v[84:85], v12 offset:24576
    ds_read_b64_tr_b16 v[86:87], v12 offset:26624
    s_waitcnt lgkmcnt(8)
    v_mfma_f32_32x32x16_bf16 v[192:207], v[92:95], v[132:135], v[192:207]
    ds_read_b64_tr_b16 v[88:89], v13 offset:24576
    ds_read_b64_tr_b16 v[90:91], v13 offset:26624
    s_waitcnt lgkmcnt(8)
    v_mfma_f32_32x32x16_bf16 v[208:223], v[96:99], v[132:135], v[208:223]
    ds_read_b64_tr_b16 v[92:93], v14 offset:24576
    ds_read_b64_tr_b16 v[94:95], v14 offset:26624
    s_waitcnt lgkmcnt(8)
    v_mfma_f32_32x32x16_bf16 v[224:239], v[100:103], v[132:135], v[224:239]
    ds_read_b64_tr_b16 v[96:97], v11 offset:28672
    ds_read_b64_tr_b16 v[98:99], v11 offset:30720
    s_waitcnt lgkmcnt(8)
    v_mfma_f32_32x32x16_bf16 v[176:191], v[80:83], v[136:139], v[176:191]
    ds_read_b64_tr_b16 v[100:101], v12 offset:28672
    ds_read_b64_tr_b16 v[102:103], v12 offset:30720
    s_waitcnt lgkmcnt(8)
    v_mfma_f32_32x32x16_bf16 v[192:207], v[84:87], v[136:139], v[192:207]
    ds_read_b64_tr_b16 v[80:81], v13 offset:28672
    ds_read_b64_tr_b16 v[82:83], v13 offset:30720
    s_waitcnt lgkmcnt(8)
    v_mfma_f32_32x32x16_bf16 v[208:223], v[88:91], v[136:139], v[208:223]
    ds_read_b64_tr_b16 v[84:85], v14 offset:28672
    ds_read_b64_tr_b16 v[86:87], v14 offset:30720
    s_waitcnt lgkmcnt(8)
    v_mfma_f32_32x32x16_bf16 v[224:239], v[92:95], v[136:139], v[224:239]
    ds_read_b64_tr_b16 v[88:89], v11 offset:32768
    ds_read_b64_tr_b16 v[90:91], v11 offset:34816
    s_waitcnt lgkmcnt(8)
    v_mfma_f32_32x32x16_bf16 v[176:191], v[96:99], v[140:143], v[176:191]
    ds_read_b64_tr_b16 v[92:93], v12 offset:32768
    ds_read_b64_tr_b16 v[94:95], v12 offset:34816
    s_waitcnt lgkmcnt(8)
    v_mfma_f32_32x32x16_bf16 v[192:207], v[100:103], v[140:143], v[192:207]
    ds_read_b64_tr_b16 v[96:97], v13 offset:32768
    ds_read_b64_tr_b16 v[98:99], v13 offset:34816
    s_waitcnt lgkmcnt(8)
    v_mfma_f32_32x32x16_bf16 v[208:223], v[80:83], v[140:143], v[208:223]
    ds_read_b64_tr_b16 v[100:101], v14 offset:32768
    ds_read_b64_tr_b16 v[102:103], v14 offset:34816
    s_waitcnt lgkmcnt(8)
    v_mfma_f32_32x32x16_bf16 v[224:239], v[84:87], v[140:143], v[224:239]
    ds_read_b64_tr_b16 v[80:81], v11 offset:36864
    ds_read_b64_tr_b16 v[82:83], v11 offset:38912
    s_waitcnt lgkmcnt(8)
    v_mfma_f32_32x32x16_bf16 v[176:191], v[88:91], v[144:147], v[176:191]
    ds_read_b64_tr_b16 v[84:85], v12 offset:36864
    ds_read_b64_tr_b16 v[86:87], v12 offset:38912
    s_waitcnt lgkmcnt(8)
    v_mfma_f32_32x32x16_bf16 v[192:207], v[92:95], v[144:147], v[192:207]
    ds_read_b64_tr_b16 v[88:89], v13 offset:36864
    ds_read_b64_tr_b16 v[90:91], v13 offset:38912
    s_waitcnt lgkmcnt(8)
    v_mfma_f32_32x32x16_bf16 v[208:223], v[96:99], v[144:147], v[208:223]
    ds_read_b64_tr_b16 v[92:93], v14 offset:36864
    ds_read_b64_tr_b16 v[94:95], v14 offset:38912
    s_waitcnt lgkmcnt(8)
    v_mfma_f32_32x32x16_bf16 v[224:239], v[100:103], v[144:147], v[224:239]
    ds_read_b64_tr_b16 v[96:97], v11 offset:40960
    ds_read_b64_tr_b16 v[98:99], v11 offset:43008
    s_waitcnt lgkmcnt(8)
    v_mfma_f32_32x32x16_bf16 v[176:191], v[80:83], v[148:151], v[176:191]
    ds_read_b64_tr_b16 v[100:101], v12 offset:40960
    ds_read_b64_tr_b16 v[102:103], v12 offset:43008
    s_waitcnt lgkmcnt(8)
    v_mfma_f32_32x32x16_bf16 v[192:207], v[84:87], v[148:151], v[192:207]
    ds_read_b64_tr_b16 v[80:81], v13 offset:40960
    ds_read_b64_tr_b16 v[82:83], v13 offset:43008
    s_waitcnt lgkmcnt(8)
    v_mfma_f32_32x32x16_bf16 v[208:223], v[88:91], v[148:151], v[208:223]
    ds_read_b64_tr_b16 v[84:85], v14 offset:40960
    ds_read_b64_tr_b16 v[86:87], v14 offset:43008
    s_waitcnt lgkmcnt(8)
    v_mfma_f32_32x32x16_bf16 v[224:239], v[92:95], v[148:151], v[224:239]
    ds_read_b64_tr_b16 v[88:89], v11 offset:45056
    ds_read_b64_tr_b16 v[90:91], v11 offset:47104
    s_waitcnt lgkmcnt(8)
    v_mfma_f32_32x32x16_bf16 v[176:191], v[96:99], v[152:155], v[176:191]
    ds_read_b64_tr_b16 v[92:93], v12 offset:45056
    ds_read_b64_tr_b16 v[94:95], v12 offset:47104
    s_waitcnt lgkmcnt(8)
    v_mfma_f32_32x32x16_bf16 v[192:207], v[100:103], v[152:155], v[192:207]
    ds_read_b64_tr_b16 v[96:97], v13 offset:45056
    ds_read_b64_tr_b16 v[98:99], v13 offset:47104
    s_waitcnt lgkmcnt(8)
    v_mfma_f32_32x32x16_bf16 v[208:223], v[80:83], v[152:155], v[208:223]
    ds_read_b64_tr_b16 v[100:101], v14 offset:45056
    ds_read_b64_tr_b16 v[102:103], v14 offset:47104
    s_waitcnt lgkmcnt(8)
    v_mfma_f32_32x32x16_bf16 v[224:239], v[84:87], v[152:155], v[224:239]
    ds_read_b64_tr_b16 v[80:81], v11 offset:49152
    ds_read_b64_tr_b16 v[82:83], v11 offset:51200
    s_waitcnt lgkmcnt(8)
    v_mfma_f32_32x32x16_bf16 v[176:191], v[88:91], v[156:159], v[176:191]
    ds_read_b64_tr_b16 v[84:85], v12 offset:49152
    ds_read_b64_tr_b16 v[86:87], v12 offset:51200
    s_waitcnt lgkmcnt(8)
    v_mfma_f32_32x32x16_bf16 v[192:207], v[92:95], v[156:159], v[192:207]
    ds_read_b64_tr_b16 v[88:89], v13 offset:49152
    ds_read_b64_tr_b16 v[90:91], v13 offset:51200
    s_waitcnt lgkmcnt(8)
    v_mfma_f32_32x32x16_bf16 v[208:223], v[96:99], v[156:159], v[208:223]
    ds_read_b64_tr_b16 v[92:93], v14 offset:49152
    ds_read_b64_tr_b16 v[94:95], v14 offset:51200
    s_waitcnt lgkmcnt(8)
    v_mfma_f32_32x32x16_bf16 v[224:239], v[100:103], v[156:159], v[224:239]
    ds_read_b64_tr_b16 v[96:97], v11 offset:53248
    ds_read_b64_tr_b16 v[98:99], v11 offset:55296
    s_waitcnt lgkmcnt(8)
    v_mfma_f32_32x32x16_bf16 v[176:191], v[80:83], v[160:163], v[176:191]
    ds_read_b64_tr_b16 v[100:101], v12 offset:53248
    ds_read_b64_tr_b16 v[102:103], v12 offset:55296
    s_waitcnt lgkmcnt(8)
    v_mfma_f32_32x32x16_bf16 v[192:207], v[84:87], v[160:163], v[192:207]
    ds_read_b64_tr_b16 v[80:81], v13 offset:53248
    ds_read_b64_tr_b16 v[82:83], v13 offset:55296
    s_waitcnt lgkmcnt(8)
    v_mfma_f32_32x32x16_bf16 v[208:223], v[88:91], v[160:163], v[208:223]
    ds_read_b64_tr_b16 v[84:85], v14 offset:53248
    ds_read_b64_tr_b16 v[86:87], v14 offset:55296
    s_waitcnt lgkmcnt(8)
    v_mfma_f32_32x32x16_bf16 v[224:239], v[92:95], v[160:163], v[224:239]
    ds_read_b64_tr_b16 v[88:89], v11 offset:57344
    ds_read_b64_tr_b16 v[90:91], v11 offset:59392
    s_waitcnt lgkmcnt(8)
    v_mfma_f32_32x32x16_bf16 v[176:191], v[96:99], v[164:167], v[176:191]
    ds_read_b64_tr_b16 v[92:93], v12 offset:57344
    ds_read_b64_tr_b16 v[94:95], v12 offset:59392
    s_waitcnt lgkmcnt(8)
    v_mfma_f32_32x32x16_bf16 v[192:207], v[100:103], v[164:167], v[192:207]
    ds_read_b64_tr_b16 v[96:97], v13 offset:57344
    ds_read_b64_tr_b16 v[98:99], v13 offset:59392
    s_waitcnt lgkmcnt(8)
    v_mfma_f32_32x32x16_bf16 v[208:223], v[80:83], v[164:167], v[208:223]
    ds_read_b64_tr_b16 v[100:101], v14 offset:57344
    ds_read_b64_tr_b16 v[102:103], v14 offset:59392
    s_waitcnt lgkmcnt(8)
    v_mfma_f32_32x32x16_bf16 v[224:239], v[84:87], v[164:167], v[224:239]
    ds_read_b64_tr_b16 v[80:81], v11 offset:61440
    ds_read_b64_tr_b16 v[82:83], v11 offset:63488
    s_waitcnt lgkmcnt(8)
    v_mfma_f32_32x32x16_bf16 v[176:191], v[88:91], v[168:171], v[176:191]
    ds_read_b64_tr_b16 v[84:85], v12 offset:61440
    ds_read_b64_tr_b16 v[86:87], v12 offset:63488
    s_waitcnt lgkmcnt(8)
    v_mfma_f32_32x32x16_bf16 v[192:207], v[92:95], v[168:171], v[192:207]
    ds_read_b64_tr_b16 v[88:89], v13 offset:61440
    ds_read_b64_tr_b16 v[90:91], v13 offset:63488
    s_waitcnt lgkmcnt(8)
    v_mfma_f32_32x32x16_bf16 v[208:223], v[96:99], v[168:171], v[208:223]
    ds_read_b64_tr_b16 v[92:93], v14 offset:61440
    ds_read_b64_tr_b16 v[94:95], v14 offset:63488
    s_waitcnt lgkmcnt(8)
    v_mfma_f32_32x32x16_bf16 v[224:239], v[100:103], v[168:171], v[224:239]
    s_waitcnt lgkmcnt(6)
    v_mfma_f32_32x32x16_bf16 v[176:191], v[80:83], v[172:175], v[176:191]
    s_waitcnt lgkmcnt(4)
    v_mfma_f32_32x32x16_bf16 v[192:207], v[84:87], v[172:175], v[192:207]
    s_waitcnt lgkmcnt(2)
    v_mfma_f32_32x32x16_bf16 v[208:223], v[88:91], v[172:175], v[208:223]
    s_waitcnt lgkmcnt(0)
    v_mfma_f32_32x32x16_bf16 v[224:239], v[92:95], v[172:175], v[224:239]
    s_nop 7
    s_nop 7
    s_add_u32 s38, s30, 16384
    s_add_u32 s39, s30, 20480
    v_mul_f32 v176, v176, v111
    v_mul_f32 v177, v177, v111
    v_mul_f32 v178, v178, v111
    v_mul_f32 v179, v179, v111
    v_mul_f32 v180, v180, v111
    v_mul_f32 v181, v181, v111
    v_mul_f32 v182, v182, v111
    v_mul_f32 v183, v183, v111
    v_mul_f32 v184, v184, v111
    v_mul_f32 v185, v185, v111
    v_mul_f32 v186, v186, v111
    v_mul_f32 v187, v187, v111
    v_mul_f32 v188, v188, v111
    v_mul_f32 v189, v189, v111
    v_mul_f32 v190, v190, v111
    v_mul_f32 v191, v191, v111
    v_cvt_pk_bf16_f32 v176, v176, v177
    v_cvt_pk_bf16_f32 v177, v178, v179
    v_cvt_pk_bf16_f32 v178, v180, v181
    v_cvt_pk_bf16_f32 v179, v182, v183
    v_cvt_pk_bf16_f32 v180, v184, v185
    v_cvt_pk_bf16_f32 v181, v186, v187
    v_cvt_pk_bf16_f32 v182, v188, v189
    v_cvt_pk_bf16_f32 v183, v190, v191
    ds_write_b128 v240, v[176:179]
    ds_write_b128 v241, v[180:183]
    v_mul_f32 v192, v192, v111
    v_mul_f32 v193, v193, v111
    v_mul_f32 v194, v194, v111
    v_mul_f32 v195, v195, v111
    v_mul_f32 v196, v196, v111
    v_mul_f32 v197, v197, v111
    v_mul_f32 v198, v198, v111
    v_mul_f32 v199, v199, v111
    v_mul_f32 v200, v200, v111
    v_mul_f32 v201, v201, v111
    v_mul_f32 v202, v202, v111
    v_mul_f32 v203, v203, v111
    v_mul_f32 v204, v204, v111
    v_mul_f32 v205, v205, v111
    v_mul_f32 v206, v206, v111
    v_mul_f32 v207, v207, v111
    v_cvt_pk_bf16_f32 v192, v192, v193
    v_cvt_pk_bf16_f32 v193, v194, v195
    v_cvt_pk_bf16_f32 v194, v196, v197
    v_cvt_pk_bf16_f32 v195, v198, v199
    v_cvt_pk_bf16_f32 v196, v200, v201
    v_cvt_pk_bf16_f32 v197, v202, v203
    v_cvt_pk_bf16_f32 v198, v204, v205
    v_cvt_pk_bf16_f32 v199, v206, v207
    ds_write_b128 v242, v[192:195]
    ds_write_b128 v243, v[196:199]
    s_waitcnt lgkmcnt(0)
    ds_read_b128 v[80:83], v2 offset:0
    ds_read_b128 v[84:87], v2 offset:1024
    ds_read_b128 v[88:91], v2 offset:2048
    ds_read_b128 v[92:95], v2 offset:3072
    s_waitcnt lgkmcnt(3)
    buffer_store_dwordx4 v[80:83], v244, s[24:27], s38 offen offset:0
    s_waitcnt lgkmcnt(2)
    buffer_store_dwordx4 v[84:87], v244, s[24:27], s38 offen offset:2048
    s_waitcnt lgkmcnt(1)
    buffer_store_dwordx4 v[88:91], v244, s[24:27], s39 offen offset:0
    s_waitcnt lgkmcnt(0)
    buffer_store_dwordx4 v[92:95], v244, s[24:27], s39 offen offset:2048
    v_mul_f32 v208, v208, v111
    v_mul_f32 v209, v209, v111
    v_mul_f32 v210, v210, v111
    v_mul_f32 v211, v211, v111
    v_mul_f32 v212, v212, v111
    v_mul_f32 v213, v213, v111
    v_mul_f32 v214, v214, v111
    v_mul_f32 v215, v215, v111
    v_mul_f32 v216, v216, v111
    v_mul_f32 v217, v217, v111
    v_mul_f32 v218, v218, v111
    v_mul_f32 v219, v219, v111
    v_mul_f32 v220, v220, v111
    v_mul_f32 v221, v221, v111
    v_mul_f32 v222, v222, v111
    v_mul_f32 v223, v223, v111
    v_cvt_pk_bf16_f32 v208, v208, v209
    v_cvt_pk_bf16_f32 v209, v210, v211
    v_cvt_pk_bf16_f32 v210, v212, v213
    v_cvt_pk_bf16_f32 v211, v214, v215
    v_cvt_pk_bf16_f32 v212, v216, v217
    v_cvt_pk_bf16_f32 v213, v218, v219
    v_cvt_pk_bf16_f32 v214, v220, v221
    v_cvt_pk_bf16_f32 v215, v222, v223
    ds_write_b128 v240, v[208:211]
    ds_write_b128 v241, v[212:215]
    v_mul_f32 v224, v224, v111
    v_mul_f32 v225, v225, v111
    v_mul_f32 v226, v226, v111
    v_mul_f32 v227, v227, v111
    v_mul_f32 v228, v228, v111
    v_mul_f32 v229, v229, v111
    v_mul_f32 v230, v230, v111
    v_mul_f32 v231, v231, v111
    v_mul_f32 v232, v232, v111
    v_mul_f32 v233, v233, v111
    v_mul_f32 v234, v234, v111
    v_mul_f32 v235, v235, v111
    v_mul_f32 v236, v236, v111
    v_mul_f32 v237, v237, v111
    v_mul_f32 v238, v238, v111
    v_mul_f32 v239, v239, v111
    v_cvt_pk_bf16_f32 v224, v224, v225
    v_cvt_pk_bf16_f32 v225, v226, v227
    v_cvt_pk_bf16_f32 v226, v228, v229
    v_cvt_pk_bf16_f32 v227, v230, v231
    v_cvt_pk_bf16_f32 v228, v232, v233
    v_cvt_pk_bf16_f32 v229, v234, v235
    v_cvt_pk_bf16_f32 v230, v236, v237
    v_cvt_pk_bf16_f32 v231, v238, v239
    ds_write_b128 v242, v[224:227]
    ds_write_b128 v243, v[228:231]
    s_waitcnt lgkmcnt(0)
    ds_read_b128 v[80:83], v2 offset:0
    ds_read_b128 v[84:87], v2 offset:1024
    ds_read_b128 v[88:91], v2 offset:2048
    ds_read_b128 v[92:95], v2 offset:3072
    s_waitcnt lgkmcnt(3)
    buffer_store_dwordx4 v[80:83], v244, s[24:27], s38 offen offset:128
    s_waitcnt lgkmcnt(2)
    buffer_store_dwordx4 v[84:87], v244, s[24:27], s38 offen offset:2176
    s_waitcnt lgkmcnt(1)
    buffer_store_dwordx4 v[88:91], v244, s[24:27], s39 offen offset:128
    s_waitcnt lgkmcnt(0)
    buffer_store_dwordx4 v[92:95], v244, s[24:27], s39 offen offset:2176
    s_waitcnt vmcnt(24)
    ds_read_b128 v[80:83], v3 offset:0
    ds_read_b128 v[84:87], v4 offset:0
    ds_read_b128 v[88:91], v5 offset:0
    ds_read_b128 v[92:95], v6 offset:0
    ds_read_b128 v[96:99], v7 offset:0
    s_waitcnt lgkmcnt(4)
    v_mfma_f32_32x32x16_bf16 v[112:127], v[80:83], v[48:51], 0
    ds_read_b128 v[100:103], v8 offset:0
    s_waitcnt lgkmcnt(4)
    v_mfma_f32_32x32x16_bf16 v[112:127], v[84:87], v[52:55], v[112:127]
    ds_read_b128 v[80:83], v9 offset:0
    s_waitcnt lgkmcnt(4)
    v_mfma_f32_32x32x16_bf16 v[112:127], v[88:91], v[56:59], v[112:127]
    ds_read_b128 v[84:87], v10 offset:0
    s_waitcnt lgkmcnt(4)
    v_mfma_f32_32x32x16_bf16 v[112:127], v[92:95], v[60:63], v[112:127]
    ds_read_b128 v[88:91], v3 offset:8192
    s_waitcnt lgkmcnt(4)
    v_mfma_f32_32x32x16_bf16 v[112:127], v[96:99], v[64:67], v[112:127]
    ds_read_b128 v[92:95], v4 offset:8192
    s_waitcnt lgkmcnt(4)
    v_mfma_f32_32x32x16_bf16 v[112:127], v[100:103], v[68:71], v[112:127]
    ds_read_b128 v[96:99], v5 offset:8192
    s_waitcnt lgkmcnt(4)
    v_mfma_f32_32x32x16_bf16 v[112:127], v[80:83], v[72:75], v[112:127]
    ds_read_b128 v[100:103], v6 offset:8192
    s_waitcnt lgkmcnt(4)
    v_mfma_f32_32x32x16_bf16 v[112:127], v[84:87], v[76:79], v[112:127]
    ds_read_b128 v[80:83], v7 offset:8192
    s_waitcnt lgkmcnt(4)
    v_mfma_f32_32x32x16_bf16 v[128:143], v[88:91], v[48:51], 0
    ds_read_b128 v[84:87], v8 offset:8192
    s_waitcnt lgkmcnt(4)
    v_mfma_f32_32x32x16_bf16 v[128:143], v[92:95], v[52:55], v[128:143]
    ds_read_b128 v[88:91], v9 offset:8192
    s_waitcnt lgkmcnt(4)
    v_mfma_f32_32x32x16_bf16 v[128:143], v[96:99], v[56:59], v[128:143]
    ds_read_b128 v[92:95], v10 offset:8192
    s_waitcnt lgkmcnt(4)
    v_mfma_f32_32x32x16_bf16 v[128:143], v[100:103], v[60:63], v[128:143]
    ds_read_b128 v[96:99], v3 offset:16384
    s_waitcnt lgkmcnt(4)
    v_mfma_f32_32x32x16_bf16 v[128:143], v[80:83], v[64:67], v[128:143]
    ds_read_b128 v[100:103], v4 offset:16384
    s_waitcnt lgkmcnt(4)
    v_mfma_f32_32x32x16_bf16 v[128:143], v[84:87], v[68:71], v[128:143]
    ds_read_b128 v[80:83], v5 offset:16384
    s_waitcnt lgkmcnt(4)
    v_mfma_f32_32x32x16_bf16 v[128:143], v[88:91], v[72:75], v[128:143]
    ds_read_b128 v[84:87], v6 offset:16384
    s_waitcnt lgkmcnt(4)
    v_mfma_f32_32x32x16_bf16 v[128:143], v[92:95], v[76:79], v[128:143]
    ds_read_b128 v[88:91], v7 offset:16384
    s_waitcnt lgkmcnt(4)
    v_mfma_f32_32x32x16_bf16 v[144:159], v[96:99], v[48:51], 0
    ds_read_b128 v[92:95], v8 offset:16384
    s_waitcnt lgkmcnt(4)
    v_mfma_f32_32x32x16_bf16 v[144:159], v[100:103], v[52:55], v[144:159]
    ds_read_b128 v[96:99], v9 offset:16384
    s_waitcnt lgkmcnt(4)
    v_mfma_f32_32x32x16_bf16 v[144:159], v[80:83], v[56:59], v[144:159]
    ds_read_b128 v[100:103], v10 offset:16384
    s_waitcnt lgkmcnt(4)
    v_mfma_f32_32x32x16_bf16 v[144:159], v[84:87], v[60:63], v[144:159]
    ds_read_b128 v[80:83], v3 offset:24576
    s_waitcnt lgkmcnt(4)
    v_mfma_f32_32x32x16_bf16 v[144:159], v[88:91], v[64:67], v[144:159]
    ds_read_b128 v[84:87], v4 offset:24576
    s_waitcnt lgkmcnt(4)
    v_mfma_f32_32x32x16_bf16 v[144:159], v[92:95], v[68:71], v[144:159]
    ds_read_b128 v[88:91], v5 offset:24576
    s_waitcnt lgkmcnt(4)
    v_mfma_f32_32x32x16_bf16 v[144:159], v[96:99], v[72:75], v[144:159]
    ds_read_b128 v[92:95], v6 offset:24576
    s_waitcnt lgkmcnt(4)
    v_mfma_f32_32x32x16_bf16 v[144:159], v[100:103], v[76:79], v[144:159]
    ds_read_b128 v[96:99], v7 offset:24576
    s_waitcnt lgkmcnt(4)
    v_mfma_f32_32x32x16_bf16 v[160:175], v[80:83], v[48:51], 0
    ds_read_b128 v[100:103], v8 offset:24576
    s_waitcnt lgkmcnt(4)
    v_mfma_f32_32x32x16_bf16 v[160:175], v[84:87], v[52:55], v[160:175]
    ds_read_b128 v[80:83], v9 offset:24576
    s_waitcnt lgkmcnt(4)
    v_mfma_f32_32x32x16_bf16 v[160:175], v[88:91], v[56:59], v[160:175]
    ds_read_b128 v[84:87], v10 offset:24576
    s_waitcnt lgkmcnt(4)
    v_mfma_f32_32x32x16_bf16 v[160:175], v[92:95], v[60:63], v[160:175]
    ds_read_b128 v[88:91], v3 offset:32768
    s_waitcnt lgkmcnt(4)
    v_mfma_f32_32x32x16_bf16 v[160:175], v[96:99], v[64:67], v[160:175]
    ds_read_b128 v[92:95], v4 offset:32768
    s_waitcnt lgkmcnt(4)
    v_mfma_f32_32x32x16_bf16 v[160:175], v[100:103], v[68:71], v[160:175]
    ds_read_b128 v[96:99], v5 offset:32768
    s_waitcnt lgkmcnt(4)
    v_mfma_f32_32x32x16_bf16 v[160:175], v[80:83], v[72:75], v[160:175]
    ds_read_b128 v[100:103], v6 offset:32768
    s_waitcnt lgkmcnt(4)
    v_mfma_f32_32x32x16_bf16 v[160:175], v[84:87], v[76:79], v[160:175]
    ds_read_b128 v[80:83], v7 offset:32768
    s_waitcnt lgkmcnt(4)
    v_mfma_f32_32x32x16_bf16 v[176:191], v[88:91], v[48:51], 0
    ds_read_b128 v[84:87], v8 offset:32768
    s_waitcnt lgkmcnt(4)
    v_mfma_f32_32x32x16_bf16 v[176:191], v[92:95], v[52:55], v[176:191]
    ds_read_b128 v[88:91], v9 offset:32768
    s_waitcnt lgkmcnt(4)
    v_mfma_f32_32x32x16_bf16 v[176:191], v[96:99], v[56:59], v[176:191]
    ds_read_b128 v[92:95], v10 offset:32768
    s_waitcnt lgkmcnt(4)
    v_mfma_f32_32x32x16_bf16 v[176:191], v[100:103], v[60:63], v[176:191]
    ds_read_b128 v[96:99], v3 offset:40960
    s_waitcnt lgkmcnt(4)
    v_mfma_f32_32x32x16_bf16 v[176:191], v[80:83], v[64:67], v[176:191]
    ds_read_b128 v[100:103], v4 offset:40960
    s_waitcnt lgkmcnt(4)
    v_mfma_f32_32x32x16_bf16 v[176:191], v[84:87], v[68:71], v[176:191]
    ds_read_b128 v[80:83], v5 offset:40960
    s_waitcnt lgkmcnt(4)
    v_mfma_f32_32x32x16_bf16 v[176:191], v[88:91], v[72:75], v[176:191]
    ds_read_b128 v[84:87], v6 offset:40960
    s_waitcnt lgkmcnt(4)
    v_mfma_f32_32x32x16_bf16 v[176:191], v[92:95], v[76:79], v[176:191]
    ds_read_b128 v[88:91], v7 offset:40960
    s_waitcnt lgkmcnt(4)
    v_mfma_f32_32x32x16_bf16 v[192:207], v[96:99], v[48:51], 0
    ds_read_b128 v[92:95], v8 offset:40960
    s_waitcnt lgkmcnt(4)
    v_mfma_f32_32x32x16_bf16 v[192:207], v[100:103], v[52:55], v[192:207]
    ds_read_b128 v[96:99], v9 offset:40960
    s_waitcnt lgkmcnt(4)
    v_mfma_f32_32x32x16_bf16 v[192:207], v[80:83], v[56:59], v[192:207]
    ds_read_b128 v[100:103], v10 offset:40960
    s_waitcnt lgkmcnt(4)
    v_mfma_f32_32x32x16_bf16 v[192:207], v[84:87], v[60:63], v[192:207]
    ds_read_b128 v[80:83], v3 offset:49152
    s_waitcnt lgkmcnt(4)
    v_mfma_f32_32x32x16_bf16 v[192:207], v[88:91], v[64:67], v[192:207]
    ds_read_b128 v[84:87], v4 offset:49152
    s_waitcnt lgkmcnt(4)
    v_mfma_f32_32x32x16_bf16 v[192:207], v[92:95], v[68:71], v[192:207]
    ds_read_b128 v[88:91], v5 offset:49152
    s_waitcnt lgkmcnt(4)
    v_mfma_f32_32x32x16_bf16 v[192:207], v[96:99], v[72:75], v[192:207]
    ds_read_b128 v[92:95], v6 offset:49152
    s_waitcnt lgkmcnt(4)
    v_mfma_f32_32x32x16_bf16 v[192:207], v[100:103], v[76:79], v[192:207]
    ds_read_b128 v[96:99], v7 offset:49152
    s_waitcnt lgkmcnt(4)
    v_mfma_f32_32x32x16_bf16 v[208:223], v[80:83], v[48:51], 0
    ds_read_b128 v[100:103], v8 offset:49152
    s_waitcnt lgkmcnt(4)
    v_mfma_f32_32x32x16_bf16 v[208:223], v[84:87], v[52:55], v[208:223]
    ds_read_b128 v[80:83], v9 offset:49152
    s_waitcnt lgkmcnt(4)
    v_mfma_f32_32x32x16_bf16 v[208:223], v[88:91], v[56:59], v[208:223]
    ds_read_b128 v[84:87], v10 offset:49152
    s_waitcnt lgkmcnt(4)
    v_mfma_f32_32x32x16_bf16 v[208:223], v[92:95], v[60:63], v[208:223]
    ds_read_b128 v[88:91], v3 offset:57344
    s_waitcnt lgkmcnt(4)
    v_mfma_f32_32x32x16_bf16 v[208:223], v[96:99], v[64:67], v[208:223]
    ds_read_b128 v[92:95], v4 offset:57344
    s_waitcnt lgkmcnt(4)
    v_mfma_f32_32x32x16_bf16 v[208:223], v[100:103], v[68:71], v[208:223]
    ds_read_b128 v[96:99], v5 offset:57344
    s_waitcnt lgkmcnt(4)
    v_mfma_f32_32x32x16_bf16 v[208:223], v[80:83], v[72:75], v[208:223]
    ds_read_b128 v[100:103], v6 offset:57344
    s_waitcnt lgkmcnt(4)
    v_mfma_f32_32x32x16_bf16 v[208:223], v[84:87], v[76:79], v[208:223]
    ds_read_b128 v[80:83], v7 offset:57344
    s_waitcnt lgkmcnt(4)
    v_mfma_f32_32x32x16_bf16 v[224:239], v[88:91], v[48:51], 0
    ds_read_b128 v[84:87], v8 offset:57344
    s_waitcnt lgkmcnt(4)
    v_mfma_f32_32x32x16_bf16 v[224:239], v[92:95], v[52:55], v[224:239]
    ds_read_b128 v[88:91], v9 offset:57344
    s_waitcnt lgkmcnt(4)
    v_mfma_f32_32x32x16_bf16 v[224:239], v[96:99], v[56:59], v[224:239]
    ds_read_b128 v[92:95], v10 offset:57344
    s_waitcnt lgkmcnt(4)
    v_mfma_f32_32x32x16_bf16 v[224:239], v[100:103], v[60:63], v[224:239]
    s_waitcnt lgkmcnt(3)
    v_mfma_f32_32x32x16_bf16 v[224:239], v[80:83], v[64:67], v[224:239]
    s_waitcnt lgkmcnt(2)
    v_mfma_f32_32x32x16_bf16 v[224:239], v[84:87], v[68:71], v[224:239]
    s_waitcnt lgkmcnt(1)
    v_mfma_f32_32x32x16_bf16 v[224:239], v[88:91], v[72:75], v[224:239]
    s_waitcnt lgkmcnt(0)
    v_mfma_f32_32x32x16_bf16 v[224:239], v[92:95], v[76:79], v[224:239]
    s_barrier
    s_add_u32 s34, s35, 0x1000000
    s_add_u32 m0, s40, 0
    s_add_u32 s33, s34, 0
    buffer_load_dwordx4 v245, s[16:19], s33 offen lds
    s_add_u32 m0, s40, 8192
    s_add_u32 s33, s34, 8192
    buffer_load_dwordx4 v245, s[16:19], s33 offen lds
    s_add_u32 m0, s40, 16384
    s_add_u32 s33, s34, 16384
    buffer_load_dwordx4 v245, s[16:19], s33 offen lds
    s_add_u32 m0, s40, 24576
    s_add_u32 s33, s34, 24576
    buffer_load_dwordx4 v245, s[16:19], s33 offen lds
    s_add_u32 m0, s40, 32768
    s_add_u32 s33, s34, 32768
    buffer_load_dwordx4 v245, s[16:19], s33 offen lds
    s_add_u32 m0, s40, 40960
    s_add_u32 s33, s34, 40960
    buffer_load_dwordx4 v245, s[16:19], s33 offen lds
    s_add_u32 m0, s40, 49152
    s_add_u32 s33, s34, 49152
    buffer_load_dwordx4 v245, s[16:19], s33 offen lds
    s_add_u32 m0, s40, 57344
    s_add_u32 s33, s34, 57344
    buffer_load_dwordx4 v245, s[16:19], s33 offen lds
    s_add_u32 s34, s30, 0x4002000
    buffer_load_dwordx4 v[48:51], v1, s[12:15], s34 offen offset:0
    buffer_load_dwordx4 v[52:55], v1, s[12:15], s34 offen offset:32
    buffer_load_dwordx4 v[56:59], v1, s[12:15], s34 offen offset:64
    buffer_load_dwordx4 v[60:63], v1, s[12:15], s34 offen offset:96
    buffer_load_dwordx4 v[64:67], v1, s[12:15], s34 offen offset:128
    buffer_load_dwordx4 v[68:71], v1, s[12:15], s34 offen offset:160
    buffer_load_dwordx4 v[72:75], v1, s[12:15], s34 offen offset:192
    buffer_load_dwordx4 v[76:79], v1, s[12:15], s34 offen offset:224
    s_nop 7
    v_max3_f32 v104, v112, v113, v114
    v_max3_f32 v106, v115, v116, v117
    v_max3_f32 v104, v104, v118, v119
    v_max3_f32 v106, v106, v120, v121
    v_max3_f32 v104, v104, v122, v123
    v_max3_f32 v106, v106, v124, v125
    v_max3_f32 v104, v104, v126, v127
    v_max3_f32 v106, v106, v128, v129
    v_max3_f32 v104, v104, v130, v131
    v_max3_f32 v106, v106, v132, v133
    v_max3_f32 v104, v104, v134, v135
    v_max3_f32 v106, v106, v136, v137
    v_max3_f32 v104, v104, v138, v139
    v_max3_f32 v106, v106, v140, v141
    v_max3_f32 v104, v104, v142, v143
    v_max3_f32 v106, v106, v144, v145
    v_max3_f32 v104, v104, v146, v147
    v_max3_f32 v106, v106, v148, v149
    v_max3_f32 v104, v104, v150, v151
    v_max3_f32 v106, v106, v152, v153
    v_max3_f32 v104, v104, v154, v155
    v_max3_f32 v106, v106, v156, v157
    v_max3_f32 v104, v104, v158, v159
    v_max3_f32 v106, v106, v160, v161
    v_max3_f32 v104, v104, v162, v163
    v_max3_f32 v106, v106, v164, v165
    v_max3_f32 v104, v104, v166, v167
    v_max3_f32 v106, v106, v168, v169
    v_max3_f32 v104, v104, v170, v171
    v_max3_f32 v106, v106, v172, v173
    v_max3_f32 v104, v104, v174, v175
    v_max3_f32 v106, v106, v176, v177
    v_max3_f32 v104, v104, v178, v179
    v_max3_f32 v106, v106, v180, v181
    v_max3_f32 v104, v104, v182, v183
    v_max3_f32 v106, v106, v184, v185
    v_max3_f32 v104, v104, v186, v187
    v_max3_f32 v106, v106, v188, v189
    v_max3_f32 v104, v104, v190, v191
    v_max3_f32 v106, v106, v192, v193
    v_max3_f32 v104, v104, v194, v195
    v_max3_f32 v106, v106, v196, v197
    v_max3_f32 v104, v104, v198, v199
    v_max3_f32 v106, v106, v200, v201
    v_max3_f32 v104, v104, v202, v203
    v_max3_f32 v106, v106, v204, v205
    v_max3_f32 v104, v104, v206, v207
    v_max3_f32 v106, v106, v208, v209
    v_max3_f32 v104, v104, v210, v211
    v_max3_f32 v106, v106, v212, v213
    v_max3_f32 v104, v104, v214, v215
    v_max3_f32 v106, v106, v216, v217
    v_max3_f32 v104, v104, v218, v219
    v_max3_f32 v106, v106, v220, v221
    v_max3_f32 v104, v104, v222, v223
    v_max3_f32 v106, v106, v224, v225
    v_max3_f32 v104, v104, v226, v227
    v_max3_f32 v106, v106, v228, v229
    v_max3_f32 v104, v104, v230, v231
    v_max3_f32 v106, v106, v232, v233
    v_max3_f32 v104, v104, v234, v235
    v_max3_f32 v106, v106, v236, v237
    v_max3_f32 v104, v104, v238, v239
    v_max_f32 v104, v104, v106
    v_mov_b32 v106, v104
    s_nop 1
    v_permlane32_swap_b32 v104, v106
    v_max_f32 v104, v104, v106
    v_mul_f32 v105, s32, v104
    v_mov_b32 v107, 0
    v_mov_b32 v108, 0
    v_mov_b32 v109, 0
    v_mov_b32 v110, 0
    v_fma_f32 v112, v112, s32, -v105
    v_fma_f32 v113, v113, s32, -v105
    v_fma_f32 v114, v114, s32, -v105
    v_fma_f32 v115, v115, s32, -v105
    v_exp_f32 v112, v112
    v_exp_f32 v113, v113
    v_exp_f32 v114, v114
    v_exp_f32 v115, v115
    s_nop 0
    v_add_f32 v107, v107, v112
    v_add_f32 v108, v108, v113
    v_add_f32 v109, v109, v114
    v_add_f32 v110, v110, v115
    v_cvt_pk_bf16_f32 v112, v112, v113
    v_cvt_pk_bf16_f32 v113, v114, v115
    v_fma_f32 v116, v116, s32, -v105
    v_fma_f32 v117, v117, s32, -v105
    v_fma_f32 v118, v118, s32, -v105
    v_fma_f32 v119, v119, s32, -v105
    v_exp_f32 v116, v116
    v_exp_f32 v117, v117
    v_exp_f32 v118, v118
    v_exp_f32 v119, v119
    s_nop 0
    v_add_f32 v107, v107, v116
    v_add_f32 v108, v108, v117
    v_add_f32 v109, v109, v118
    v_add_f32 v110, v110, v119
    v_cvt_pk_bf16_f32 v114, v116, v117
    v_cvt_pk_bf16_f32 v115, v118, v119
    v_fma_f32 v120, v120, s32, -v105
    v_fma_f32 v121, v121, s32, -v105
    v_fma_f32 v122, v122, s32, -v105
    v_fma_f32 v123, v123, s32, -v105
    v_exp_f32 v120, v120
    v_exp_f32 v121, v121
    v_exp_f32 v122, v122
    v_exp_f32 v123, v123
    s_nop 0
    v_add_f32 v107, v107, v120
    v_add_f32 v108, v108, v121
    v_add_f32 v109, v109, v122
    v_add_f32 v110, v110, v123
    v_cvt_pk_bf16_f32 v116, v120, v121
    v_cvt_pk_bf16_f32 v117, v122, v123
    v_fma_f32 v124, v124, s32, -v105
    v_fma_f32 v125, v125, s32, -v105
    v_fma_f32 v126, v126, s32, -v105
    v_fma_f32 v127, v127, s32, -v105
    v_exp_f32 v124, v124
    v_exp_f32 v125, v125
    v_exp_f32 v126, v126
    v_exp_f32 v127, v127
    s_nop 0
    v_add_f32 v107, v107, v124
    v_add_f32 v108, v108, v125
    v_add_f32 v109, v109, v126
    v_add_f32 v110, v110, v127
    v_cvt_pk_bf16_f32 v118, v124, v125
    v_cvt_pk_bf16_f32 v119, v126, v127
    v_fma_f32 v128, v128, s32, -v105
    v_fma_f32 v129, v129, s32, -v105
    v_fma_f32 v130, v130, s32, -v105
    v_fma_f32 v131, v131, s32, -v105
    v_exp_f32 v128, v128
    v_exp_f32 v129, v129
    v_exp_f32 v130, v130
    v_exp_f32 v131, v131
    s_nop 0
    v_add_f32 v107, v107, v128
    v_add_f32 v108, v108, v129
    v_add_f32 v109, v109, v130
    v_add_f32 v110, v110, v131
    v_cvt_pk_bf16_f32 v120, v128, v129
    v_cvt_pk_bf16_f32 v121, v130, v131
    v_fma_f32 v132, v132, s32, -v105
    v_fma_f32 v133, v133, s32, -v105
    v_fma_f32 v134, v134, s32, -v105
    v_fma_f32 v135, v135, s32, -v105
    v_exp_f32 v132, v132
    v_exp_f32 v133, v133
    v_exp_f32 v134, v134
    v_exp_f32 v135, v135
    s_nop 0
    v_add_f32 v107, v107, v132
    v_add_f32 v108, v108, v133
    v_add_f32 v109, v109, v134
    v_add_f32 v110, v110, v135
    v_cvt_pk_bf16_f32 v122, v132, v133
    v_cvt_pk_bf16_f32 v123, v134, v135
    v_fma_f32 v136, v136, s32, -v105
    v_fma_f32 v137, v137, s32, -v105
    v_fma_f32 v138, v138, s32, -v105
    v_fma_f32 v139, v139, s32, -v105
    v_exp_f32 v136, v136
    v_exp_f32 v137, v137
    v_exp_f32 v138, v138
    v_exp_f32 v139, v139
    s_nop 0
    v_add_f32 v107, v107, v136
    v_add_f32 v108, v108, v137
    v_add_f32 v109, v109, v138
    v_add_f32 v110, v110, v139
    v_cvt_pk_bf16_f32 v124, v136, v137
    v_cvt_pk_bf16_f32 v125, v138, v139
    v_fma_f32 v140, v140, s32, -v105
    v_fma_f32 v141, v141, s32, -v105
    v_fma_f32 v142, v142, s32, -v105
    v_fma_f32 v143, v143, s32, -v105
    v_exp_f32 v140, v140
    v_exp_f32 v141, v141
    v_exp_f32 v142, v142
    v_exp_f32 v143, v143
    s_nop 0
    v_add_f32 v107, v107, v140
    v_add_f32 v108, v108, v141
    v_add_f32 v109, v109, v142
    v_add_f32 v110, v110, v143
    v_cvt_pk_bf16_f32 v126, v140, v141
    v_cvt_pk_bf16_f32 v127, v142, v143
    v_fma_f32 v144, v144, s32, -v105
    v_fma_f32 v145, v145, s32, -v105
    v_fma_f32 v146, v146, s32, -v105
    v_fma_f32 v147, v147, s32, -v105
    v_exp_f32 v144, v144
    v_exp_f32 v145, v145
    v_exp_f32 v146, v146
    v_exp_f32 v147, v147
    s_nop 0
    v_add_f32 v107, v107, v144
    v_add_f32 v108, v108, v145
    v_add_f32 v109, v109, v146
    v_add_f32 v110, v110, v147
    v_cvt_pk_bf16_f32 v128, v144, v145
    v_cvt_pk_bf16_f32 v129, v146, v147
    v_fma_f32 v148, v148, s32, -v105
    v_fma_f32 v149, v149, s32, -v105
    v_fma_f32 v150, v150, s32, -v105
    v_fma_f32 v151, v151, s32, -v105
    v_exp_f32 v148, v148
    v_exp_f32 v149, v149
    v_exp_f32 v150, v150
    v_exp_f32 v151, v151
    s_nop 0
    v_add_f32 v107, v107, v148
    v_add_f32 v108, v108, v149
    v_add_f32 v109, v109, v150
    v_add_f32 v110, v110, v151
    v_cvt_pk_bf16_f32 v130, v148, v149
    v_cvt_pk_bf16_f32 v131, v150, v151
    v_fma_f32 v152, v152, s32, -v105
    v_fma_f32 v153, v153, s32, -v105
    v_fma_f32 v154, v154, s32, -v105
    v_fma_f32 v155, v155, s32, -v105
    v_exp_f32 v152, v152
    v_exp_f32 v153, v153
    v_exp_f32 v154, v154
    v_exp_f32 v155, v155
    s_nop 0
    v_add_f32 v107, v107, v152
    v_add_f32 v108, v108, v153
    v_add_f32 v109, v109, v154
    v_add_f32 v110, v110, v155
    v_cvt_pk_bf16_f32 v132, v152, v153
    v_cvt_pk_bf16_f32 v133, v154, v155
    v_fma_f32 v156, v156, s32, -v105
    v_fma_f32 v157, v157, s32, -v105
    v_fma_f32 v158, v158, s32, -v105
    v_fma_f32 v159, v159, s32, -v105
    v_exp_f32 v156, v156
    v_exp_f32 v157, v157
    v_exp_f32 v158, v158
    v_exp_f32 v159, v159
    s_nop 0
    v_add_f32 v107, v107, v156
    v_add_f32 v108, v108, v157
    v_add_f32 v109, v109, v158
    v_add_f32 v110, v110, v159
    v_cvt_pk_bf16_f32 v134, v156, v157
    v_cvt_pk_bf16_f32 v135, v158, v159
    v_fma_f32 v160, v160, s32, -v105
    v_fma_f32 v161, v161, s32, -v105
    v_fma_f32 v162, v162, s32, -v105
    v_fma_f32 v163, v163, s32, -v105
    v_exp_f32 v160, v160
    v_exp_f32 v161, v161
    v_exp_f32 v162, v162
    v_exp_f32 v163, v163
    s_nop 0
    v_add_f32 v107, v107, v160
    v_add_f32 v108, v108, v161
    v_add_f32 v109, v109, v162
    v_add_f32 v110, v110, v163
    v_cvt_pk_bf16_f32 v136, v160, v161
    v_cvt_pk_bf16_f32 v137, v162, v163
    v_fma_f32 v164, v164, s32, -v105
    v_fma_f32 v165, v165, s32, -v105
    v_fma_f32 v166, v166, s32, -v105
    v_fma_f32 v167, v167, s32, -v105
    v_exp_f32 v164, v164
    v_exp_f32 v165, v165
    v_exp_f32 v166, v166
    v_exp_f32 v167, v167
    s_nop 0
    v_add_f32 v107, v107, v164
    v_add_f32 v108, v108, v165
    v_add_f32 v109, v109, v166
    v_add_f32 v110, v110, v167
    v_cvt_pk_bf16_f32 v138, v164, v165
    v_cvt_pk_bf16_f32 v139, v166, v167
    v_fma_f32 v168, v168, s32, -v105
    v_fma_f32 v169, v169, s32, -v105
    v_fma_f32 v170, v170, s32, -v105
    v_fma_f32 v171, v171, s32, -v105
    v_exp_f32 v168, v168
    v_exp_f32 v169, v169
    v_exp_f32 v170, v170
    v_exp_f32 v171, v171
    s_nop 0
    v_add_f32 v107, v107, v168
    v_add_f32 v108, v108, v169
    v_add_f32 v109, v109, v170
    v_add_f32 v110, v110, v171
    v_cvt_pk_bf16_f32 v140, v168, v169
    v_cvt_pk_bf16_f32 v141, v170, v171
    v_fma_f32 v172, v172, s32, -v105
    v_fma_f32 v173, v173, s32, -v105
    v_fma_f32 v174, v174, s32, -v105
    v_fma_f32 v175, v175, s32, -v105
    v_exp_f32 v172, v172
    v_exp_f32 v173, v173
    v_exp_f32 v174, v174
    v_exp_f32 v175, v175
    s_nop 0
    v_add_f32 v107, v107, v172
    v_add_f32 v108, v108, v173
    v_add_f32 v109, v109, v174
    v_add_f32 v110, v110, v175
    v_cvt_pk_bf16_f32 v142, v172, v173
    v_cvt_pk_bf16_f32 v143, v174, v175
    v_fma_f32 v176, v176, s32, -v105
    v_fma_f32 v177, v177, s32, -v105
    v_fma_f32 v178, v178, s32, -v105
    v_fma_f32 v179, v179, s32, -v105
    v_exp_f32 v176, v176
    v_exp_f32 v177, v177
    v_exp_f32 v178, v178
    v_exp_f32 v179, v179
    s_nop 0
    v_add_f32 v107, v107, v176
    v_add_f32 v108, v108, v177
    v_add_f32 v109, v109, v178
    v_add_f32 v110, v110, v179
    v_cvt_pk_bf16_f32 v144, v176, v177
    v_cvt_pk_bf16_f32 v145, v178, v179
    v_fma_f32 v180, v180, s32, -v105
    v_fma_f32 v181, v181, s32, -v105
    v_fma_f32 v182, v182, s32, -v105
    v_fma_f32 v183, v183, s32, -v105
    v_exp_f32 v180, v180
    v_exp_f32 v181, v181
    v_exp_f32 v182, v182
    v_exp_f32 v183, v183
    s_nop 0
    v_add_f32 v107, v107, v180
    v_add_f32 v108, v108, v181
    v_add_f32 v109, v109, v182
    v_add_f32 v110, v110, v183
    v_cvt_pk_bf16_f32 v146, v180, v181
    v_cvt_pk_bf16_f32 v147, v182, v183
    v_fma_f32 v184, v184, s32, -v105
    v_fma_f32 v185, v185, s32, -v105
    v_fma_f32 v186, v186, s32, -v105
    v_fma_f32 v187, v187, s32, -v105
    v_exp_f32 v184, v184
    v_exp_f32 v185, v185
    v_exp_f32 v186, v186
    v_exp_f32 v187, v187
    s_nop 0
    v_add_f32 v107, v107, v184
    v_add_f32 v108, v108, v185
    v_add_f32 v109, v109, v186
    v_add_f32 v110, v110, v187
    v_cvt_pk_bf16_f32 v148, v184, v185
    v_cvt_pk_bf16_f32 v149, v186, v187
    v_fma_f32 v188, v188, s32, -v105
    v_fma_f32 v189, v189, s32, -v105
    v_fma_f32 v190, v190, s32, -v105
    v_fma_f32 v191, v191, s32, -v105
    v_exp_f32 v188, v188
    v_exp_f32 v189, v189
    v_exp_f32 v190, v190
    v_exp_f32 v191, v191
    s_nop 0
    v_add_f32 v107, v107, v188
    v_add_f32 v108, v108, v189
    v_add_f32 v109, v109, v190
    v_add_f32 v110, v110, v191
    v_cvt_pk_bf16_f32 v150, v188, v189
    v_cvt_pk_bf16_f32 v151, v190, v191
    v_fma_f32 v192, v192, s32, -v105
    v_fma_f32 v193, v193, s32, -v105
    v_fma_f32 v194, v194, s32, -v105
    v_fma_f32 v195, v195, s32, -v105
    v_exp_f32 v192, v192
    v_exp_f32 v193, v193
    v_exp_f32 v194, v194
    v_exp_f32 v195, v195
    s_nop 0
    v_add_f32 v107, v107, v192
    v_add_f32 v108, v108, v193
    v_add_f32 v109, v109, v194
    v_add_f32 v110, v110, v195
    v_cvt_pk_bf16_f32 v152, v192, v193
    v_cvt_pk_bf16_f32 v153, v194, v195
    v_fma_f32 v196, v196, s32, -v105
    v_fma_f32 v197, v197, s32, -v105
    v_fma_f32 v198, v198, s32, -v105
    v_fma_f32 v199, v199, s32, -v105
    v_exp_f32 v196, v196
    v_exp_f32 v197, v197
    v_exp_f32 v198, v198
    v_exp_f32 v199, v199
    s_nop 0
    v_add_f32 v107, v107, v196
    v_add_f32 v108, v108, v197
    v_add_f32 v109, v109, v198
    v_add_f32 v110, v110, v199
    v_cvt_pk_bf16_f32 v154, v196, v197
    v_cvt_pk_bf16_f32 v155, v198, v199
    v_fma_f32 v200, v200, s32, -v105
    v_fma_f32 v201, v201, s32, -v105
    v_fma_f32 v202, v202, s32, -v105
    v_fma_f32 v203, v203, s32, -v105
    v_exp_f32 v200, v200
    v_exp_f32 v201, v201
    v_exp_f32 v202, v202
    v_exp_f32 v203, v203
    s_nop 0
    v_add_f32 v107, v107, v200
    v_add_f32 v108, v108, v201
    v_add_f32 v109, v109, v202
    v_add_f32 v110, v110, v203
    v_cvt_pk_bf16_f32 v156, v200, v201
    v_cvt_pk_bf16_f32 v157, v202, v203
    v_fma_f32 v204, v204, s32, -v105
    v_fma_f32 v205, v205, s32, -v105
    v_fma_f32 v206, v206, s32, -v105
    v_fma_f32 v207, v207, s32, -v105
    v_exp_f32 v204, v204
    v_exp_f32 v205, v205
    v_exp_f32 v206, v206
    v_exp_f32 v207, v207
    s_nop 0
    v_add_f32 v107, v107, v204
    v_add_f32 v108, v108, v205
    v_add_f32 v109, v109, v206
    v_add_f32 v110, v110, v207
    v_cvt_pk_bf16_f32 v158, v204, v205
    v_cvt_pk_bf16_f32 v159, v206, v207
    v_fma_f32 v208, v208, s32, -v105
    v_fma_f32 v209, v209, s32, -v105
    v_fma_f32 v210, v210, s32, -v105
    v_fma_f32 v211, v211, s32, -v105
    v_exp_f32 v208, v208
    v_exp_f32 v209, v209
    v_exp_f32 v210, v210
    v_exp_f32 v211, v211
    s_nop 0
    v_add_f32 v107, v107, v208
    v_add_f32 v108, v108, v209
    v_add_f32 v109, v109, v210
    v_add_f32 v110, v110, v211
    v_cvt_pk_bf16_f32 v160, v208, v209
    v_cvt_pk_bf16_f32 v161, v210, v211
    v_fma_f32 v212, v212, s32, -v105
    v_fma_f32 v213, v213, s32, -v105
    v_fma_f32 v214, v214, s32, -v105
    v_fma_f32 v215, v215, s32, -v105
    v_exp_f32 v212, v212
    v_exp_f32 v213, v213
    v_exp_f32 v214, v214
    v_exp_f32 v215, v215
    s_nop 0
    v_add_f32 v107, v107, v212
    v_add_f32 v108, v108, v213
    v_add_f32 v109, v109, v214
    v_add_f32 v110, v110, v215
    v_cvt_pk_bf16_f32 v162, v212, v213
    v_cvt_pk_bf16_f32 v163, v214, v215
    v_fma_f32 v216, v216, s32, -v105
    v_fma_f32 v217, v217, s32, -v105
    v_fma_f32 v218, v218, s32, -v105
    v_fma_f32 v219, v219, s32, -v105
    v_exp_f32 v216, v216
    v_exp_f32 v217, v217
    v_exp_f32 v218, v218
    v_exp_f32 v219, v219
    s_nop 0
    v_add_f32 v107, v107, v216
    v_add_f32 v108, v108, v217
    v_add_f32 v109, v109, v218
    v_add_f32 v110, v110, v219
    v_cvt_pk_bf16_f32 v164, v216, v217
    v_cvt_pk_bf16_f32 v165, v218, v219
    v_fma_f32 v220, v220, s32, -v105
    v_fma_f32 v221, v221, s32, -v105
    v_fma_f32 v222, v222, s32, -v105
    v_fma_f32 v223, v223, s32, -v105
    v_exp_f32 v220, v220
    v_exp_f32 v221, v221
    v_exp_f32 v222, v222
    v_exp_f32 v223, v223
    s_nop 0
    v_add_f32 v107, v107, v220
    v_add_f32 v108, v108, v221
    v_add_f32 v109, v109, v222
    v_add_f32 v110, v110, v223
    v_cvt_pk_bf16_f32 v166, v220, v221
    v_cvt_pk_bf16_f32 v167, v222, v223
    v_fma_f32 v224, v224, s32, -v105
    v_fma_f32 v225, v225, s32, -v105
    v_fma_f32 v226, v226, s32, -v105
    v_fma_f32 v227, v227, s32, -v105
    v_exp_f32 v224, v224
    v_exp_f32 v225, v225
    v_exp_f32 v226, v226
    v_exp_f32 v227, v227
    s_nop 0
    v_add_f32 v107, v107, v224
    v_add_f32 v108, v108, v225
    v_add_f32 v109, v109, v226
    v_add_f32 v110, v110, v227
    v_cvt_pk_bf16_f32 v168, v224, v225
    v_cvt_pk_bf16_f32 v169, v226, v227
    v_fma_f32 v228, v228, s32, -v105
    v_fma_f32 v229, v229, s32, -v105
    v_fma_f32 v230, v230, s32, -v105
    v_fma_f32 v231, v231, s32, -v105
    v_exp_f32 v228, v228
    v_exp_f32 v229, v229
    v_exp_f32 v230, v230
    v_exp_f32 v231, v231
    s_nop 0
    v_add_f32 v107, v107, v228
    v_add_f32 v108, v108, v229
    v_add_f32 v109, v109, v230
    v_add_f32 v110, v110, v231
    v_cvt_pk_bf16_f32 v170, v228, v229
    v_cvt_pk_bf16_f32 v171, v230, v231
    v_fma_f32 v232, v232, s32, -v105
    v_fma_f32 v233, v233, s32, -v105
    v_fma_f32 v234, v234, s32, -v105
    v_fma_f32 v235, v235, s32, -v105
    v_exp_f32 v232, v232
    v_exp_f32 v233, v233
    v_exp_f32 v234, v234
    v_exp_f32 v235, v235
    s_nop 0
    v_add_f32 v107, v107, v232
    v_add_f32 v108, v108, v233
    v_add_f32 v109, v109, v234
    v_add_f32 v110, v110, v235
    v_cvt_pk_bf16_f32 v172, v232, v233
    v_cvt_pk_bf16_f32 v173, v234, v235
    v_fma_f32 v236, v236, s32, -v105
    v_fma_f32 v237, v237, s32, -v105
    v_fma_f32 v238, v238, s32, -v105
    v_fma_f32 v239, v239, s32, -v105
    v_exp_f32 v236, v236
    v_exp_f32 v237, v237
    v_exp_f32 v238, v238
    v_exp_f32 v239, v239
    s_nop 0
    v_add_f32 v107, v107, v236
    v_add_f32 v108, v108, v237
    v_add_f32 v109, v109, v238
    v_add_f32 v110, v110, v239
    v_cvt_pk_bf16_f32 v174, v236, v237
    v_cvt_pk_bf16_f32 v175, v238, v239
    v_add_f32 v107, v107, v108
    v_add_f32 v109, v109, v110
    v_add_f32 v107, v107, v109
    v_mov_b32 v106, v107
    s_nop 1
    v_permlane32_swap_b32 v107, v106
    v_add_f32 v107, v107, v106
    v_rcp_f32 v111, v107
    ds_read_b64_tr_b16 v[80:81], v11 offset:0
    ds_read_b64_tr_b16 v[82:83], v11 offset:2048
    ds_read_b64_tr_b16 v[84:85], v12 offset:0
    ds_read_b64_tr_b16 v[86:87], v12 offset:2048
    ds_read_b64_tr_b16 v[88:89], v13 offset:0
    ds_read_b64_tr_b16 v[90:91], v13 offset:2048
    ds_read_b64_tr_b16 v[92:93], v14 offset:0
    ds_read_b64_tr_b16 v[94:95], v14 offset:2048
    ds_read_b64_tr_b16 v[96:97], v11 offset:4096
    ds_read_b64_tr_b16 v[98:99], v11 offset:6144
    s_waitcnt lgkmcnt(8)
    v_mfma_f32_32x32x16_bf16 v[176:191], v[80:83], v[112:115], 0
    ds_read_b64_tr_b16 v[100:101], v12 offset:4096
    ds_read_b64_tr_b16 v[102:103], v12 offset:6144
    s_waitcnt lgkmcnt(8)
    v_mfma_f32_32x32x16_bf16 v[192:207], v[84:87], v[112:115], 0
    ds_read_b64_tr_b16 v[80:81], v13 offset:4096
    ds_read_b64_tr_b16 v[82:83], v13 offset:6144
    s_waitcnt lgkmcnt(8)
    v_mfma_f32_32x32x16_bf16 v[208:223], v[88:91], v[112:115], 0
    ds_read_b64_tr_b16 v[84:85], v14 offset:4096
    ds_read_b64_tr_b16 v[86:87], v14 offset:6144
    s_waitcnt lgkmcnt(8)
    v_mfma_f32_32x32x16_bf16 v[224:239], v[92:95], v[112:115], 0
    ds_read_b64_tr_b16 v[88:89], v11 offset:8192
    ds_read_b64_tr_b16 v[90:91], v11 offset:10240
    s_waitcnt lgkmcnt(8)
    v_mfma_f32_32x32x16_bf16 v[176:191], v[96:99], v[116:119], v[176:191]
    ds_read_b64_tr_b16 v[92:93], v12 offset:8192
    ds_read_b64_tr_b16 v[94:95], v12 offset:10240
    s_waitcnt lgkmcnt(8)
    v_mfma_f32_32x32x16_bf16 v[192:207], v[100:103], v[116:119], v[192:207]
    ds_read_b64_tr_b16 v[96:97], v13 offset:8192
    ds_read_b64_tr_b16 v[98:99], v13 offset:10240
    s_waitcnt lgkmcnt(8)
    v_mfma_f32_32x32x16_bf16 v[208:223], v[80:83], v[116:119], v[208:223]
    ds_read_b64_tr_b16 v[100:101], v14 offset:8192
    ds_read_b64_tr_b16 v[102:103], v14 offset:10240
    s_waitcnt lgkmcnt(8)
    v_mfma_f32_32x32x16_bf16 v[224:239], v[84:87], v[116:119], v[224:239]
    ds_read_b64_tr_b16 v[80:81], v11 offset:12288
    ds_read_b64_tr_b16 v[82:83], v11 offset:14336
    s_waitcnt lgkmcnt(8)
    v_mfma_f32_32x32x16_bf16 v[176:191], v[88:91], v[120:123], v[176:191]
    ds_read_b64_tr_b16 v[84:85], v12 offset:12288
    ds_read_b64_tr_b16 v[86:87], v12 offset:14336
    s_waitcnt lgkmcnt(8)
    v_mfma_f32_32x32x16_bf16 v[192:207], v[92:95], v[120:123], v[192:207]
    ds_read_b64_tr_b16 v[88:89], v13 offset:12288
    ds_read_b64_tr_b16 v[90:91], v13 offset:14336
    s_waitcnt lgkmcnt(8)
    v_mfma_f32_32x32x16_bf16 v[208:223], v[96:99], v[120:123], v[208:223]
    ds_read_b64_tr_b16 v[92:93], v14 offset:12288
    ds_read_b64_tr_b16 v[94:95], v14 offset:14336
    s_waitcnt lgkmcnt(8)
    v_mfma_f32_32x32x16_bf16 v[224:239], v[100:103], v[120:123], v[224:239]
    ds_read_b64_tr_b16 v[96:97], v11 offset:16384
    ds_read_b64_tr_b16 v[98:99], v11 offset:18432
    s_waitcnt lgkmcnt(8)
    v_mfma_f32_32x32x16_bf16 v[176:191], v[80:83], v[124:127], v[176:191]
    ds_read_b64_tr_b16 v[100:101], v12 offset:16384
    ds_read_b64_tr_b16 v[102:103], v12 offset:18432
    s_waitcnt lgkmcnt(8)
    v_mfma_f32_32x32x16_bf16 v[192:207], v[84:87], v[124:127], v[192:207]
    ds_read_b64_tr_b16 v[80:81], v13 offset:16384
    ds_read_b64_tr_b16 v[82:83], v13 offset:18432
    s_waitcnt lgkmcnt(8)
    v_mfma_f32_32x32x16_bf16 v[208:223], v[88:91], v[124:127], v[208:223]
    ds_read_b64_tr_b16 v[84:85], v14 offset:16384
    ds_read_b64_tr_b16 v[86:87], v14 offset:18432
    s_waitcnt lgkmcnt(8)
    v_mfma_f32_32x32x16_bf16 v[224:239], v[92:95], v[124:127], v[224:239]
    ds_read_b64_tr_b16 v[88:89], v11 offset:20480
    ds_read_b64_tr_b16 v[90:91], v11 offset:22528
    s_waitcnt lgkmcnt(8)
    v_mfma_f32_32x32x16_bf16 v[176:191], v[96:99], v[128:131], v[176:191]
    ds_read_b64_tr_b16 v[92:93], v12 offset:20480
    ds_read_b64_tr_b16 v[94:95], v12 offset:22528
    s_waitcnt lgkmcnt(8)
    v_mfma_f32_32x32x16_bf16 v[192:207], v[100:103], v[128:131], v[192:207]
    ds_read_b64_tr_b16 v[96:97], v13 offset:20480
    ds_read_b64_tr_b16 v[98:99], v13 offset:22528
    s_waitcnt lgkmcnt(8)
    v_mfma_f32_32x32x16_bf16 v[208:223], v[80:83], v[128:131], v[208:223]
    ds_read_b64_tr_b16 v[100:101], v14 offset:20480
    ds_read_b64_tr_b16 v[102:103], v14 offset:22528
    s_waitcnt lgkmcnt(8)
    v_mfma_f32_32x32x16_bf16 v[224:239], v[84:87], v[128:131], v[224:239]
    ds_read_b64_tr_b16 v[80:81], v11 offset:24576
    ds_read_b64_tr_b16 v[82:83], v11 offset:26624
    s_waitcnt lgkmcnt(8)
    v_mfma_f32_32x32x16_bf16 v[176:191], v[88:91], v[132:135], v[176:191]
    ds_read_b64_tr_b16 v[84:85], v12 offset:24576
    ds_read_b64_tr_b16 v[86:87], v12 offset:26624
    s_waitcnt lgkmcnt(8)
    v_mfma_f32_32x32x16_bf16 v[192:207], v[92:95], v[132:135], v[192:207]
    ds_read_b64_tr_b16 v[88:89], v13 offset:24576
    ds_read_b64_tr_b16 v[90:91], v13 offset:26624
    s_waitcnt lgkmcnt(8)
    v_mfma_f32_32x32x16_bf16 v[208:223], v[96:99], v[132:135], v[208:223]
    ds_read_b64_tr_b16 v[92:93], v14 offset:24576
    ds_read_b64_tr_b16 v[94:95], v14 offset:26624
    s_waitcnt lgkmcnt(8)
    v_mfma_f32_32x32x16_bf16 v[224:239], v[100:103], v[132:135], v[224:239]
    ds_read_b64_tr_b16 v[96:97], v11 offset:28672
    ds_read_b64_tr_b16 v[98:99], v11 offset:30720
    s_waitcnt lgkmcnt(8)
    v_mfma_f32_32x32x16_bf16 v[176:191], v[80:83], v[136:139], v[176:191]
    ds_read_b64_tr_b16 v[100:101], v12 offset:28672
    ds_read_b64_tr_b16 v[102:103], v12 offset:30720
    s_waitcnt lgkmcnt(8)
    v_mfma_f32_32x32x16_bf16 v[192:207], v[84:87], v[136:139], v[192:207]
    ds_read_b64_tr_b16 v[80:81], v13 offset:28672
    ds_read_b64_tr_b16 v[82:83], v13 offset:30720
    s_waitcnt lgkmcnt(8)
    v_mfma_f32_32x32x16_bf16 v[208:223], v[88:91], v[136:139], v[208:223]
    ds_read_b64_tr_b16 v[84:85], v14 offset:28672
    ds_read_b64_tr_b16 v[86:87], v14 offset:30720
    s_waitcnt lgkmcnt(8)
    v_mfma_f32_32x32x16_bf16 v[224:239], v[92:95], v[136:139], v[224:239]
    ds_read_b64_tr_b16 v[88:89], v11 offset:32768
    ds_read_b64_tr_b16 v[90:91], v11 offset:34816
    s_waitcnt lgkmcnt(8)
    v_mfma_f32_32x32x16_bf16 v[176:191], v[96:99], v[140:143], v[176:191]
    ds_read_b64_tr_b16 v[92:93], v12 offset:32768
    ds_read_b64_tr_b16 v[94:95], v12 offset:34816
    s_waitcnt lgkmcnt(8)
    v_mfma_f32_32x32x16_bf16 v[192:207], v[100:103], v[140:143], v[192:207]
    ds_read_b64_tr_b16 v[96:97], v13 offset:32768
    ds_read_b64_tr_b16 v[98:99], v13 offset:34816
    s_waitcnt lgkmcnt(8)
    v_mfma_f32_32x32x16_bf16 v[208:223], v[80:83], v[140:143], v[208:223]
    ds_read_b64_tr_b16 v[100:101], v14 offset:32768
    ds_read_b64_tr_b16 v[102:103], v14 offset:34816
    s_waitcnt lgkmcnt(8)
    v_mfma_f32_32x32x16_bf16 v[224:239], v[84:87], v[140:143], v[224:239]
    ds_read_b64_tr_b16 v[80:81], v11 offset:36864
    ds_read_b64_tr_b16 v[82:83], v11 offset:38912
    s_waitcnt lgkmcnt(8)
    v_mfma_f32_32x32x16_bf16 v[176:191], v[88:91], v[144:147], v[176:191]
    ds_read_b64_tr_b16 v[84:85], v12 offset:36864
    ds_read_b64_tr_b16 v[86:87], v12 offset:38912
    s_waitcnt lgkmcnt(8)
    v_mfma_f32_32x32x16_bf16 v[192:207], v[92:95], v[144:147], v[192:207]
    ds_read_b64_tr_b16 v[88:89], v13 offset:36864
    ds_read_b64_tr_b16 v[90:91], v13 offset:38912
    s_waitcnt lgkmcnt(8)
    v_mfma_f32_32x32x16_bf16 v[208:223], v[96:99], v[144:147], v[208:223]
    ds_read_b64_tr_b16 v[92:93], v14 offset:36864
    ds_read_b64_tr_b16 v[94:95], v14 offset:38912
    s_waitcnt lgkmcnt(8)
    v_mfma_f32_32x32x16_bf16 v[224:239], v[100:103], v[144:147], v[224:239]
    ds_read_b64_tr_b16 v[96:97], v11 offset:40960
    ds_read_b64_tr_b16 v[98:99], v11 offset:43008
    s_waitcnt lgkmcnt(8)
    v_mfma_f32_32x32x16_bf16 v[176:191], v[80:83], v[148:151], v[176:191]
    ds_read_b64_tr_b16 v[100:101], v12 offset:40960
    ds_read_b64_tr_b16 v[102:103], v12 offset:43008
    s_waitcnt lgkmcnt(8)
    v_mfma_f32_32x32x16_bf16 v[192:207], v[84:87], v[148:151], v[192:207]
    ds_read_b64_tr_b16 v[80:81], v13 offset:40960
    ds_read_b64_tr_b16 v[82:83], v13 offset:43008
    s_waitcnt lgkmcnt(8)
    v_mfma_f32_32x32x16_bf16 v[208:223], v[88:91], v[148:151], v[208:223]
    ds_read_b64_tr_b16 v[84:85], v14 offset:40960
    ds_read_b64_tr_b16 v[86:87], v14 offset:43008
    s_waitcnt lgkmcnt(8)
    v_mfma_f32_32x32x16_bf16 v[224:239], v[92:95], v[148:151], v[224:239]
    ds_read_b64_tr_b16 v[88:89], v11 offset:45056
    ds_read_b64_tr_b16 v[90:91], v11 offset:47104
    s_waitcnt lgkmcnt(8)
    v_mfma_f32_32x32x16_bf16 v[176:191], v[96:99], v[152:155], v[176:191]
    ds_read_b64_tr_b16 v[92:93], v12 offset:45056
    ds_read_b64_tr_b16 v[94:95], v12 offset:47104
    s_waitcnt lgkmcnt(8)
    v_mfma_f32_32x32x16_bf16 v[192:207], v[100:103], v[152:155], v[192:207]
    ds_read_b64_tr_b16 v[96:97], v13 offset:45056
    ds_read_b64_tr_b16 v[98:99], v13 offset:47104
    s_waitcnt lgkmcnt(8)
    v_mfma_f32_32x32x16_bf16 v[208:223], v[80:83], v[152:155], v[208:223]
    ds_read_b64_tr_b16 v[100:101], v14 offset:45056
    ds_read_b64_tr_b16 v[102:103], v14 offset:47104
    s_waitcnt lgkmcnt(8)
    v_mfma_f32_32x32x16_bf16 v[224:239], v[84:87], v[152:155], v[224:239]
    ds_read_b64_tr_b16 v[80:81], v11 offset:49152
    ds_read_b64_tr_b16 v[82:83], v11 offset:51200
    s_waitcnt lgkmcnt(8)
    v_mfma_f32_32x32x16_bf16 v[176:191], v[88:91], v[156:159], v[176:191]
    ds_read_b64_tr_b16 v[84:85], v12 offset:49152
    ds_read_b64_tr_b16 v[86:87], v12 offset:51200
    s_waitcnt lgkmcnt(8)
    v_mfma_f32_32x32x16_bf16 v[192:207], v[92:95], v[156:159], v[192:207]
    ds_read_b64_tr_b16 v[88:89], v13 offset:49152
    ds_read_b64_tr_b16 v[90:91], v13 offset:51200
    s_waitcnt lgkmcnt(8)
    v_mfma_f32_32x32x16_bf16 v[208:223], v[96:99], v[156:159], v[208:223]
    ds_read_b64_tr_b16 v[92:93], v14 offset:49152
    ds_read_b64_tr_b16 v[94:95], v14 offset:51200
    s_waitcnt lgkmcnt(8)
    v_mfma_f32_32x32x16_bf16 v[224:239], v[100:103], v[156:159], v[224:239]
    ds_read_b64_tr_b16 v[96:97], v11 offset:53248
    ds_read_b64_tr_b16 v[98:99], v11 offset:55296
    s_waitcnt lgkmcnt(8)
    v_mfma_f32_32x32x16_bf16 v[176:191], v[80:83], v[160:163], v[176:191]
    ds_read_b64_tr_b16 v[100:101], v12 offset:53248
    ds_read_b64_tr_b16 v[102:103], v12 offset:55296
    s_waitcnt lgkmcnt(8)
    v_mfma_f32_32x32x16_bf16 v[192:207], v[84:87], v[160:163], v[192:207]
    ds_read_b64_tr_b16 v[80:81], v13 offset:53248
    ds_read_b64_tr_b16 v[82:83], v13 offset:55296
    s_waitcnt lgkmcnt(8)
    v_mfma_f32_32x32x16_bf16 v[208:223], v[88:91], v[160:163], v[208:223]
    ds_read_b64_tr_b16 v[84:85], v14 offset:53248
    ds_read_b64_tr_b16 v[86:87], v14 offset:55296
    s_waitcnt lgkmcnt(8)
    v_mfma_f32_32x32x16_bf16 v[224:239], v[92:95], v[160:163], v[224:239]
    ds_read_b64_tr_b16 v[88:89], v11 offset:57344
    ds_read_b64_tr_b16 v[90:91], v11 offset:59392
    s_waitcnt lgkmcnt(8)
    v_mfma_f32_32x32x16_bf16 v[176:191], v[96:99], v[164:167], v[176:191]
    ds_read_b64_tr_b16 v[92:93], v12 offset:57344
    ds_read_b64_tr_b16 v[94:95], v12 offset:59392
    s_waitcnt lgkmcnt(8)
    v_mfma_f32_32x32x16_bf16 v[192:207], v[100:103], v[164:167], v[192:207]
    ds_read_b64_tr_b16 v[96:97], v13 offset:57344
    ds_read_b64_tr_b16 v[98:99], v13 offset:59392
    s_waitcnt lgkmcnt(8)
    v_mfma_f32_32x32x16_bf16 v[208:223], v[80:83], v[164:167], v[208:223]
    ds_read_b64_tr_b16 v[100:101], v14 offset:57344
    ds_read_b64_tr_b16 v[102:103], v14 offset:59392
    s_waitcnt lgkmcnt(8)
    v_mfma_f32_32x32x16_bf16 v[224:239], v[84:87], v[164:167], v[224:239]
    ds_read_b64_tr_b16 v[80:81], v11 offset:61440
    ds_read_b64_tr_b16 v[82:83], v11 offset:63488
    s_waitcnt lgkmcnt(8)
    v_mfma_f32_32x32x16_bf16 v[176:191], v[88:91], v[168:171], v[176:191]
    ds_read_b64_tr_b16 v[84:85], v12 offset:61440
    ds_read_b64_tr_b16 v[86:87], v12 offset:63488
    s_waitcnt lgkmcnt(8)
    v_mfma_f32_32x32x16_bf16 v[192:207], v[92:95], v[168:171], v[192:207]
    ds_read_b64_tr_b16 v[88:89], v13 offset:61440
    ds_read_b64_tr_b16 v[90:91], v13 offset:63488
    s_waitcnt lgkmcnt(8)
    v_mfma_f32_32x32x16_bf16 v[208:223], v[96:99], v[168:171], v[208:223]
    ds_read_b64_tr_b16 v[92:93], v14 offset:61440
    ds_read_b64_tr_b16 v[94:95], v14 offset:63488
    s_waitcnt lgkmcnt(8)
    v_mfma_f32_32x32x16_bf16 v[224:239], v[100:103], v[168:171], v[224:239]
    s_waitcnt lgkmcnt(6)
    v_mfma_f32_32x32x16_bf16 v[176:191], v[80:83], v[172:175], v[176:191]
    s_waitcnt lgkmcnt(4)
    v_mfma_f32_32x32x16_bf16 v[192:207], v[84:87], v[172:175], v[192:207]
    s_waitcnt lgkmcnt(2)
    v_mfma_f32_32x32x16_bf16 v[208:223], v[88:91], v[172:175], v[208:223]
    s_waitcnt lgkmcnt(0)
    v_mfma_f32_32x32x16_bf16 v[224:239], v[92:95], v[172:175], v[224:239]
    s_barrier
    s_add_u32 s34, s35, 0x1000000
    s_add_u32 m0, s40, 65536
    s_add_u32 s33, s34, 0
    buffer_load_dwordx4 v246, s[20:23], s33 offen lds
    s_add_u32 m0, s40, 73728
    s_add_u32 s33, s34, 8192
    buffer_load_dwordx4 v246, s[20:23], s33 offen lds
    s_add_u32 m0, s40, 81920
    s_add_u32 s33, s34, 16384
    buffer_load_dwordx4 v246, s[20:23], s33 offen lds
    s_add_u32 m0, s40, 90112
    s_add_u32 s33, s34, 24576
    buffer_load_dwordx4 v246, s[20:23], s33 offen lds
    s_add_u32 m0, s40, 98304
    s_add_u32 s33, s34, 32768
    buffer_load_dwordx4 v246, s[20:23], s33 offen lds
    s_add_u32 m0, s40, 106496
    s_add_u32 s33, s34, 40960
    buffer_load_dwordx4 v246, s[20:23], s33 offen lds
    s_add_u32 m0, s40, 114688
    s_add_u32 s33, s34, 49152
    buffer_load_dwordx4 v246, s[20:23], s33 offen lds
    s_add_u32 m0, s40, 122880
    s_add_u32 s33, s34, 57344
    buffer_load_dwordx4 v246, s[20:23], s33 offen lds
    s_add_u32 s38, s30, 24576
    s_add_u32 s39, s30, 28672
    v_mul_f32 v176, v176, v111
    v_mul_f32 v177, v177, v111
    v_mul_f32 v178, v178, v111
    v_mul_f32 v179, v179, v111
    v_mul_f32 v180, v180, v111
    v_mul_f32 v181, v181, v111
    v_mul_f32 v182, v182, v111
    v_mul_f32 v183, v183, v111
    v_mul_f32 v184, v184, v111
    v_mul_f32 v185, v185, v111
    v_mul_f32 v186, v186, v111
    v_mul_f32 v187, v187, v111
    v_mul_f32 v188, v188, v111
    v_mul_f32 v189, v189, v111
    v_mul_f32 v190, v190, v111
    v_mul_f32 v191, v191, v111
    v_cvt_pk_bf16_f32 v176, v176, v177
    v_cvt_pk_bf16_f32 v177, v178, v179
    v_cvt_pk_bf16_f32 v178, v180, v181
    v_cvt_pk_bf16_f32 v179, v182, v183
    v_cvt_pk_bf16_f32 v180, v184, v185
    v_cvt_pk_bf16_f32 v181, v186, v187
    v_cvt_pk_bf16_f32 v182, v188, v189
    v_cvt_pk_bf16_f32 v183, v190, v191
    ds_write_b128 v240, v[176:179]
    ds_write_b128 v241, v[180:183]
    v_mul_f32 v192, v192, v111
    v_mul_f32 v193, v193, v111
    v_mul_f32 v194, v194, v111
    v_mul_f32 v195, v195, v111
    v_mul_f32 v196, v196, v111
    v_mul_f32 v197, v197, v111
    v_mul_f32 v198, v198, v111
    v_mul_f32 v199, v199, v111
    v_mul_f32 v200, v200, v111
    v_mul_f32 v201, v201, v111
    v_mul_f32 v202, v202, v111
    v_mul_f32 v203, v203, v111
    v_mul_f32 v204, v204, v111
    v_mul_f32 v205, v205, v111
    v_mul_f32 v206, v206, v111
    v_mul_f32 v207, v207, v111
    v_cvt_pk_bf16_f32 v192, v192, v193
    v_cvt_pk_bf16_f32 v193, v194, v195
    v_cvt_pk_bf16_f32 v194, v196, v197
    v_cvt_pk_bf16_f32 v195, v198, v199
    v_cvt_pk_bf16_f32 v196, v200, v201
    v_cvt_pk_bf16_f32 v197, v202, v203
    v_cvt_pk_bf16_f32 v198, v204, v205
    v_cvt_pk_bf16_f32 v199, v206, v207
    ds_write_b128 v242, v[192:195]
    ds_write_b128 v243, v[196:199]
    s_waitcnt lgkmcnt(0)
    ds_read_b128 v[80:83], v2 offset:0
    ds_read_b128 v[84:87], v2 offset:1024
    ds_read_b128 v[88:91], v2 offset:2048
    ds_read_b128 v[92:95], v2 offset:3072
    s_waitcnt lgkmcnt(3)
    buffer_store_dwordx4 v[80:83], v244, s[24:27], s38 offen offset:0
    s_waitcnt lgkmcnt(2)
    buffer_store_dwordx4 v[84:87], v244, s[24:27], s38 offen offset:2048
    s_waitcnt lgkmcnt(1)
    buffer_store_dwordx4 v[88:91], v244, s[24:27], s39 offen offset:0
    s_waitcnt lgkmcnt(0)
    buffer_store_dwordx4 v[92:95], v244, s[24:27], s39 offen offset:2048
    v_mul_f32 v208, v208, v111
    v_mul_f32 v209, v209, v111
    v_mul_f32 v210, v210, v111
    v_mul_f32 v211, v211, v111
    v_mul_f32 v212, v212, v111
    v_mul_f32 v213, v213, v111
    v_mul_f32 v214, v214, v111
    v_mul_f32 v215, v215, v111
    v_mul_f32 v216, v216, v111
    v_mul_f32 v217, v217, v111
    v_mul_f32 v218, v218, v111
    v_mul_f32 v219, v219, v111
    v_mul_f32 v220, v220, v111
    v_mul_f32 v221, v221, v111
    v_mul_f32 v222, v222, v111
    v_mul_f32 v223, v223, v111
    v_cvt_pk_bf16_f32 v208, v208, v209
    v_cvt_pk_bf16_f32 v209, v210, v211
    v_cvt_pk_bf16_f32 v210, v212, v213
    v_cvt_pk_bf16_f32 v211, v214, v215
    v_cvt_pk_bf16_f32 v212, v216, v217
    v_cvt_pk_bf16_f32 v213, v218, v219
    v_cvt_pk_bf16_f32 v214, v220, v221
    v_cvt_pk_bf16_f32 v215, v222, v223
    ds_write_b128 v240, v[208:211]
    ds_write_b128 v241, v[212:215]
    v_mul_f32 v224, v224, v111
    v_mul_f32 v225, v225, v111
    v_mul_f32 v226, v226, v111
    v_mul_f32 v227, v227, v111
    v_mul_f32 v228, v228, v111
    v_mul_f32 v229, v229, v111
    v_mul_f32 v230, v230, v111
    v_mul_f32 v231, v231, v111
    v_mul_f32 v232, v232, v111
    v_mul_f32 v233, v233, v111
    v_mul_f32 v234, v234, v111
    v_mul_f32 v235, v235, v111
    v_mul_f32 v236, v236, v111
    v_mul_f32 v237, v237, v111
    v_mul_f32 v238, v238, v111
    v_mul_f32 v239, v239, v111
    v_cvt_pk_bf16_f32 v224, v224, v225
    v_cvt_pk_bf16_f32 v225, v226, v227
    v_cvt_pk_bf16_f32 v226, v228, v229
    v_cvt_pk_bf16_f32 v227, v230, v231
    v_cvt_pk_bf16_f32 v228, v232, v233
    v_cvt_pk_bf16_f32 v229, v234, v235
    v_cvt_pk_bf16_f32 v230, v236, v237
    v_cvt_pk_bf16_f32 v231, v238, v239
    ds_write_b128 v242, v[224:227]
    ds_write_b128 v243, v[228:231]
    s_waitcnt lgkmcnt(0)
    ds_read_b128 v[80:83], v2 offset:0
    ds_read_b128 v[84:87], v2 offset:1024
    ds_read_b128 v[88:91], v2 offset:2048
    ds_read_b128 v[92:95], v2 offset:3072
    s_waitcnt lgkmcnt(3)
    buffer_store_dwordx4 v[80:83], v244, s[24:27], s38 offen offset:128
    s_waitcnt lgkmcnt(2)
    buffer_store_dwordx4 v[84:87], v244, s[24:27], s38 offen offset:2176
    s_waitcnt lgkmcnt(1)
    buffer_store_dwordx4 v[88:91], v244, s[24:27], s39 offen offset:128
    s_waitcnt lgkmcnt(0)
    buffer_store_dwordx4 v[92:95], v244, s[24:27], s39 offen offset:2176
    s_add_u32 s30, s30, 0x4000000
    s_add_u32 s35, s35, 0x1000000
    s_add_u32 s29, s29, 1
    s_cmp_lt_u32 s29, 2
    s_cbranch_scc1 L_group
L_end:
    s_endpgm
.section .rodata,"a"
.p2align 6
.amdhsa_kernel standalone__gqa_softmax__near_ridge_kernel
  .amdhsa_next_free_vgpr 248
  .amdhsa_next_free_sgpr 48
  .amdhsa_accum_offset 248
  .amdhsa_group_segment_fixed_size 0
  .amdhsa_kernarg_size 48
  .amdhsa_user_sgpr_count 2
  .amdhsa_user_sgpr_kernarg_segment_ptr 1
  .amdhsa_system_sgpr_workgroup_id_x 1
.end_amdhsa_kernel
```
